```python
import torch

def _softmax(x, axis=-1):
    return torch.softmax(x, dim=axis)
def _gelu(x):
    return torch.nn.functional.gelu(x, approximate="tanh")
def _silu(x):
    return torch.nn.functional.silu(x)
def _sigmoid(x):
    return torch.sigmoid(x)
def _layernorm(x, axis=-1, eps=1e-5):
    m = x.mean(dim=axis, keepdim=True)
    v = x.var(dim=axis, keepdim=True, unbiased=False)
    return (x - m) / torch.sqrt(v + eps)
def _scatter_add(tgt, idx, src, axis=0):
    return tgt.clone().index_add_(axis, idx, src)
def _segment_sum(src, seg, n):
    out = torch.zeros((n,) + src.shape[1:], dtype=src.dtype)
    return out.index_add_(0, seg, src)
def _pad(x, pw):
    flat = tuple(v for pair in reversed(pw) for v in pair)
    return torch.nn.functional.pad(x, flat)

kernel_name = 'standalone__mpnn_edge_mlp__graph'

def setup_inputs():

    _w = (lambda a: (lambda t: t.to(torch.bfloat16) if t.is_floating_point() else t)(torch.as_tensor(a)))
    N, deg, D, De = 12500, 64, 64, max(16, 1)
    E = N * deg
    return {
        "x": _w((lambda *s: torch.randn(*s, dtype=torch.bfloat16) * 0.05)(N, D)),
        "e_attr": _w((lambda *s: torch.randn(*s, dtype=torch.bfloat16) * 0.4)(E, De)),
        "src": _w((lambda lo, hi, *s: torch.randint(lo, hi, s))(0, N, E).to(torch.int64)),
        "dst": _w((lambda lo, hi, *s: torch.randint(lo, hi, s))(0, N, E).to(torch.int64)),
        "w_msg": _w((lambda *s: torch.randn(*s, dtype=torch.bfloat16) * 0.4)(2 * D + De, D)),
        "w_upd": _w((lambda *s: torch.randn(*s, dtype=torch.bfloat16) * 0.05)(2 * D, D)),
    }

def reference(x, e_attr, src, dst, w_msg, w_upd):
    N, D = x.shape
    m_in = torch.concatenate([x[src], x[dst], e_attr], axis=-1)
    msg = _silu(m_in @ w_msg)
    agg = _segment_sum(msg, dst, N)
    return _silu(torch.concatenate([x, agg], axis=-1) @ w_upd)
```

```asm
; @launch grid=(512,1,1) block=(256,1,1) lds=81152
.amdgcn_target "amdgcn-amd-amdhsa--gfx950"
.text
    .p2align 8
    .globl standalone__mpnn_edge_mlp__graph_kernel
    .type standalone__mpnn_edge_mlp__graph_kernel,@function
standalone__mpnn_edge_mlp__graph_kernel:
    s_cmp_ge_u32 s2, 512
    s_cbranch_scc1 K2_END
    s_load_dwordx8 s[4:11], s[0:1], 0
    s_load_dwordx8 s[12:19], s[0:1], 32
    s_load_dwordx2 s[68:69], s[0:1], 64
    s_memrealtime s[82:83]
    s_sub_u32 s80, s2, 504
    s_cmp_ge_u32 s80, 8
    s_cbranch_scc1 F_NW
    s_getpc_b64 s[80:81]
    v_lshlrev_b32 v1, 7, v0
    v_min_u32 v1, 0x2cb8, v1
    global_load_dword v254, v1, s[80:81]
F_NW:
    v_lshrrev_b32 v1, 6, v0
    v_and_b32 v240, 63, v0
    v_readfirstlane_b32 s3, v1
    v_and_b32 v242, 31, v0
    v_bfe_u32 v241, v0, 5, 1
    v_lshlrev_b32 v3, 4, v240
    v_mov_b32 v239, 0
    v_lshlrev_b32 v176, 4, v0
    s_lshl_b32 s90, s2, 14
    s_mov_b32 s76, s2
    s_lshl_b32 s45, s3, 13
    s_add_u32 s45, s45, 48384
    v_lshrrev_b32 v1, 4, v240
    v_xor_b32 v1, v1, v240
    v_and_b32 v5, 1, v1
    v_lshlrev_b32 v237, 4, v5
    v_and_b32 v1, 7, v1
    v_lshlrev_b32 v213, 4, v1
    v_xor_b32 v215, 64, v213
    v_mov_b32 v217, v213
    v_mov_b32 v219, v215
    s_waitcnt lgkmcnt(0)
    s_mov_b32 s84, s4
    s_and_b32 s85, s5, 0xffff
    s_or_b32 s85, s85, 0x800000
    s_mov_b32 s86, 0x186a00
    s_mov_b32 s87, 0x20000
    s_mov_b32 s64, s12
    s_and_b32 s65, s13, 0xffff
    s_mov_b32 s66, 0x4800
    s_mov_b32 s67, 0x20000
    s_mov_b32 s52, s10
    s_and_b32 s53, s11, 0xffff
    s_mov_b32 s54, 0x30d400
    s_mov_b32 s55, 0x20000
    s_mov_b32 s72, s8
    s_and_b32 s73, s9, 0xffff
    s_mov_b32 s74, 0x30d400
    s_mov_b32 s75, 0x20000
    s_cmp_ge_u32 s2, 196
    s_cbranch_scc1 F_L1
    s_add_u32 s91, s90, 0
    buffer_load_dwordx4 v[96:99], v176, s[52:55], s91 offen nt
    s_add_u32 s91, s90, 4096
    buffer_load_dwordx4 v[100:103], v176, s[52:55], s91 offen nt
    s_add_u32 s91, s90, 8192
    buffer_load_dwordx4 v[104:107], v176, s[52:55], s91 offen nt
    s_add_u32 s91, s90, 12288
    buffer_load_dwordx4 v[108:111], v176, s[52:55], s91 offen nt
    s_branch F_L2
F_L1:
    s_cmp_ge_u32 s76, 245
    s_cbranch_scc1 F_L2
    s_lshl_b32 s91, s3, 10
    s_add_u32 s91, s91, 0
    s_add_u32 m0, s91, 18432
    s_nop 0
    buffer_load_dwordx4 v3, s[64:67], s91 offen lds
    s_lshl_b32 s91, s3, 10
    s_add_u32 s91, s91, 4096
    s_add_u32 m0, s91, 18432
    s_nop 0
    buffer_load_dwordx4 v3, s[64:67], s91 offen lds
    s_sub_u32 s90, s76, 196
    s_lshl_b32 s91, s90, 2
    s_add_u32 s91, s91, s3
    s_lshl_b32 s91, s91, 6
    v_lshrrev_b32 v1, 3, v240
    v_add_u32 v1, s91, v1
    v_add_u32 v212, 0, v1
    s_add_u32 m0, s45, 0
    v_min_u32 v212, 12499, v212
    buffer_load_dwordx4 v[212:213], s[84:87], 0 idxen offen lds
    v_add_u32 v214, 8, v1
    s_add_u32 m0, s45, 1024
    v_min_u32 v214, 12499, v214
    buffer_load_dwordx4 v[214:215], s[84:87], 0 idxen offen lds
    v_add_u32 v216, 16, v1
    s_add_u32 m0, s45, 2048
    v_min_u32 v216, 12499, v216
    buffer_load_dwordx4 v[216:217], s[84:87], 0 idxen offen lds
    v_add_u32 v218, 24, v1
    s_add_u32 m0, s45, 3072
    v_min_u32 v218, 12499, v218
    buffer_load_dwordx4 v[218:219], s[84:87], 0 idxen offen lds
    v_add_u32 v212, 32, v1
    s_add_u32 m0, s45, 4096
    v_min_u32 v212, 12499, v212
    buffer_load_dwordx4 v[212:213], s[84:87], 0 idxen offen lds
    v_add_u32 v214, 40, v1
    s_add_u32 m0, s45, 5120
    v_min_u32 v214, 12499, v214
    buffer_load_dwordx4 v[214:215], s[84:87], 0 idxen offen lds
    v_add_u32 v216, 48, v1
    s_add_u32 m0, s45, 6144
    v_min_u32 v216, 12499, v216
    buffer_load_dwordx4 v[216:217], s[84:87], 0 idxen offen lds
    v_add_u32 v218, 56, v1
    s_add_u32 m0, s45, 7168
    v_min_u32 v218, 12499, v218
    buffer_load_dwordx4 v[218:219], s[84:87], 0 idxen offen lds
F_L2:
    s_mov_b32 s60, s18
    s_and_b32 s61, s19, 0xffff
    s_mov_b32 s62, 0x100
    s_mov_b32 s63, 0x20000
    s_cmp_lg_u32 s2, 253
    s_cbranch_scc1 F_NT
    s_cmp_lg_u32 s3, 0
    s_cbranch_scc1 F_NT
    s_mul_i32 s83, s83, 0x9e3779b1
    s_xor_b32 s82, s82, s83
    s_or_b32 s82, s82, 1
    v_mov_b32 v1, s82
    s_mov_b64 exec, 1
    buffer_store_dword v1, v239, s[60:63], 0 offen sc1
    s_mov_b64 exec, -1
F_NT:
    s_cmp_lt_u32 s2, 496
    s_cbranch_scc1 F_NW2
    v_lshlrev_b32 v1, 7, v0
    buffer_load_dword v254, v1, s[64:67], 0 offen
F_NW2:
    s_mov_b32 s20, s68
    s_and_b32 s21, s69, 0xffff
    s_mov_b32 s22, 0x1400000
    s_mov_b32 s23, 0x20000
    s_mov_b32 s24, s6
    s_and_b32 s25, s7, 0xffff
    s_mov_b32 s26, 0x186a000
    s_mov_b32 s27, 0x20000
    s_add_u32 s28, s68, 0x420000
    s_addc_u32 s29, s69, 0
    s_and_b32 s29, s29, 0xffff
    s_or_b32 s29, s29, 0x800000
    s_mov_b32 s30, 0x186a00
    s_mov_b32 s31, 0x20000
    s_mov_b32 s32, s4
    s_and_b32 s33, s5, 0xffff
    s_mov_b32 s34, 0x186a00
    s_mov_b32 s35, 0x20000
    s_mov_b32 s36, s16
    s_and_b32 s37, s17, 0xffff
    s_mov_b32 s38, 0x186a00
    s_mov_b32 s39, 0x20000
    s_and_b32 s4, s2, 7
    s_lshl_b32 s4, s4, 6
    s_lshr_b32 s5, s2, 3
    s_add_u32 s56, s4, s5
    s_mul_i32 s40, s56, 3125
    s_add_u32 s41, s40, 3252
    s_add_u32 s40, s40, 127
    s_lshr_b32 s40, s40, 7
    s_lshr_b32 s41, s41, 7
    s_add_u32 s48, s40, 31
    s_and_b32 s48, s48, 31
    s_mov_b32 s47, 0xffffffe0
    s_mov_b32 s49, 80
    s_mov_b32 s59, 0
    s_mov_b32 s88, 0
    s_lshl_b32 s46, s3, 11
    s_mul_i32 s77, s3, 2560
    s_add_u32 s77, s77, 37888
    v_subrev_u32 v1, s40, v242
    v_and_b32 v1, 31, v1
    v_add_u32 v1, s40, v1
    v_cmp_gt_u32 s[50:51], s41, v1
    v_lshlrev_b32 v249, 7, v1
    v_bfe_u32 v1, v242, 1, 3
    v_xor_b32 v1, v1, v241
    v_lshlrev_b32 v229, 7, v242
    v_add_u32 v229, s45, v229
    v_xor_b32 v4, 6, v1
    v_lshl_add_u32 v232, v4, 4, v229
    v_xor_b32 v4, 4, v1
    v_lshl_add_u32 v231, v4, 4, v229
    v_xor_b32 v4, 2, v1
    v_lshl_add_u32 v230, v4, 4, v229
    v_xor_b32 v4, 0, v1
    v_lshl_add_u32 v229, v4, 4, v229
    v_lshlrev_b32 v252, 10, v241
    v_bfe_u32 v1, v240, 2, 2
    v_lshl_add_u32 v252, v1, 7, v252
    v_bfe_u32 v1, v240, 4, 1
    v_lshl_add_u32 v252, v1, 5, v252
    v_and_b32 v1, 3, v240
    v_lshl_add_u32 v252, v1, 3, v252
    v_lshrrev_b32 v5, 4, v242
    v_lshlrev_b32 v5, 5, v5
    v_bfe_u32 v6, v242, 2, 1
    v_lshl_add_u32 v5, v6, 4, v5
    v_bfe_u32 v6, v242, 3, 1
    v_lshl_add_u32 v5, v6, 3, v5
    v_and_b32 v6, 3, v242
    v_lshl_add_u32 v5, v6, 1, v5
    v_add_u32 v235, s77, v5
    v_lshlrev_b32 v6, 4, v241
    v_add_u32 v236, 35328, v6
    v_mad_u32_u24 v253, v242, s49, v6
    v_add_u32 v234, s77, v253
    v_mov_b32 v238, 0x3f80
    v_sub_u32 v1, v5, v6
    v_ashrrev_i32 v1, 2, v1
    v_and_b32 v6, 2, v5
    v_lshlrev_b32 v6, 3, v6
    v_lshlrev_b32 v6, v6, v238
    v_cmp_eq_u32 vcc, 0, v1
    s_nop 1
    v_cndmask_b32 v8, 0, v6, vcc
    v_cmp_eq_u32 vcc, 1, v1
    s_nop 1
    v_cndmask_b32 v9, 0, v6, vcc
    v_cmp_eq_u32 vcc, 2, v1
    s_nop 1
    v_cndmask_b32 v10, 0, v6, vcc
    v_cmp_eq_u32 vcc, 3, v1
    s_nop 1
    v_cndmask_b32 v11, 0, v6, vcc
    v_cmp_eq_u32 vcc, 8, v1
    s_nop 1
    v_cndmask_b32 v12, 0, v6, vcc
    v_cmp_eq_u32 vcc, 9, v1
    s_nop 1
    v_cndmask_b32 v13, 0, v6, vcc
    v_cmp_eq_u32 vcc, 10, v1
    s_nop 1
    v_cndmask_b32 v14, 0, v6, vcc
    v_cmp_eq_u32 vcc, 11, v1
    s_nop 1
    v_cndmask_b32 v15, 0, v6, vcc
    v_bfe_u32 v1, v242, 3, 1
    v_xor_b32 v1, v1, v241
    v_lshlrev_b32 v1, 4, v1
    v_lshl_add_u32 v1, v242, 5, v1
    v_add_u32 v233, s46, v1
    s_mul_i32 s4, s3, 49
    v_add_u32 v1, s4, v240
    v_lshlrev_b32 v247, 17, v1
    v_lshlrev_b32 v243, 14, v1
    v_mov_b32 v246, 0
    s_cmp_ge_u32 s2, 196
    s_cbranch_scc1 F_NOTSORT
    v_lshlrev_b32 v2, 3, v0
    v_mov_b32 v4, 0
    v_mov_b32 v5, 0
    ds_write_b64 v2, v[4:5] offset:18432
    s_lshl_b32 s17, s2, 12
    v_lshl_add_u32 v5, v0, 2, s17
    s_mov_b32 s18, 800000
    v_cmp_gt_u32 s[8:9], s18, v5
    s_mov_b32 s18, 798976
    v_cmp_gt_u32 s[10:11], s18, v5
    s_mov_b32 s18, 797952
    v_cmp_gt_u32 s[12:13], s18, v5
    s_mov_b32 s18, 796928
    v_cmp_gt_u32 s[14:15], s18, v5
    s_mov_b32 s18, 0xa7c5ac5
    v_mov_b32 v4, 1
    v_lshlrev_b32 v7, 7, v0
    s_waitcnt lgkmcnt(0)
    s_barrier
    s_add_u32 s91, s90, 0
    buffer_load_dwordx4 v[112:115], v176, s[72:75], s91 offen nt
    s_add_u32 s91, s90, 4096
    buffer_load_dwordx4 v[116:119], v176, s[72:75], s91 offen nt
    s_add_u32 s91, s90, 8192
    buffer_load_dwordx4 v[120:123], v176, s[72:75], s91 offen nt
    s_add_u32 s91, s90, 12288
    buffer_load_dwordx4 v[124:127], v176, s[72:75], s91 offen nt
    s_waitcnt vmcnt(7)
    s_mov_b64 exec, s[8:9]
    v_mul_hi_u32 v128, v96, s18
    v_lshlrev_b32 v128, 2, v128
    ds_add_rtn_u32 v144, v128, v4 offset:18432
    v_mul_hi_u32 v129, v97, s18
    v_lshlrev_b32 v129, 2, v129
    ds_add_rtn_u32 v145, v129, v4 offset:18432
    v_mul_hi_u32 v130, v98, s18
    v_lshlrev_b32 v130, 2, v130
    ds_add_rtn_u32 v146, v130, v4 offset:18432
    v_mul_hi_u32 v131, v99, s18
    v_lshlrev_b32 v131, 2, v131
    ds_add_rtn_u32 v147, v131, v4 offset:18432
    s_waitcnt vmcnt(6)
    s_mov_b64 exec, s[10:11]
    v_mul_hi_u32 v132, v100, s18
    v_lshlrev_b32 v132, 2, v132
    ds_add_rtn_u32 v148, v132, v4 offset:18432
    v_mul_hi_u32 v133, v101, s18
    v_lshlrev_b32 v133, 2, v133
    ds_add_rtn_u32 v149, v133, v4 offset:18432
    v_mul_hi_u32 v134, v102, s18
    v_lshlrev_b32 v134, 2, v134
    ds_add_rtn_u32 v150, v134, v4 offset:18432
    v_mul_hi_u32 v135, v103, s18
    v_lshlrev_b32 v135, 2, v135
    ds_add_rtn_u32 v151, v135, v4 offset:18432
    s_waitcnt vmcnt(5)
    s_mov_b64 exec, s[12:13]
    v_mul_hi_u32 v136, v104, s18
    v_lshlrev_b32 v136, 2, v136
    ds_add_rtn_u32 v152, v136, v4 offset:18432
    v_mul_hi_u32 v137, v105, s18
    v_lshlrev_b32 v137, 2, v137
    ds_add_rtn_u32 v153, v137, v4 offset:18432
    v_mul_hi_u32 v138, v106, s18
    v_lshlrev_b32 v138, 2, v138
    ds_add_rtn_u32 v154, v138, v4 offset:18432
    v_mul_hi_u32 v139, v107, s18
    v_lshlrev_b32 v139, 2, v139
    ds_add_rtn_u32 v155, v139, v4 offset:18432
    s_waitcnt vmcnt(4)
    s_mov_b64 exec, s[14:15]
    v_mul_hi_u32 v140, v108, s18
    v_lshlrev_b32 v140, 2, v140
    ds_add_rtn_u32 v156, v140, v4 offset:18432
    v_mul_hi_u32 v141, v109, s18
    v_lshlrev_b32 v141, 2, v141
    ds_add_rtn_u32 v157, v141, v4 offset:18432
    v_mul_hi_u32 v142, v110, s18
    v_lshlrev_b32 v142, 2, v142
    ds_add_rtn_u32 v158, v142, v4 offset:18432
    v_mul_hi_u32 v143, v111, s18
    v_lshlrev_b32 v143, 2, v143
    ds_add_rtn_u32 v159, v143, v4 offset:18432
    s_mov_b64 exec, -1
    buffer_load_dword v177, v239, s[60:63], 0 offen sc1
    v_and_or_b32 v96, v96, 31, v7
    v_and_or_b32 v97, v97, 31, v7
    v_or_b32 v97, 0x20, v97
    v_and_or_b32 v98, v98, 31, v7
    v_or_b32 v98, 0x40, v98
    v_and_or_b32 v99, v99, 31, v7
    v_or_b32 v99, 0x60, v99
    v_and_or_b32 v100, v100, 31, v7
    v_or_b32 v100, 0x8000, v100
    v_and_or_b32 v101, v101, 31, v7
    v_or_b32 v101, 0x8020, v101
    v_and_or_b32 v102, v102, 31, v7
    v_or_b32 v102, 0x8040, v102
    v_and_or_b32 v103, v103, 31, v7
    v_or_b32 v103, 0x8060, v103
    v_and_or_b32 v104, v104, 31, v7
    v_or_b32 v104, 0x10000, v104
    v_and_or_b32 v105, v105, 31, v7
    v_or_b32 v105, 0x10020, v105
    v_and_or_b32 v106, v106, 31, v7
    v_or_b32 v106, 0x10040, v106
    v_and_or_b32 v107, v107, 31, v7
    v_or_b32 v107, 0x10060, v107
    v_and_or_b32 v108, v108, 31, v7
    v_or_b32 v108, 0x18000, v108
    v_and_or_b32 v109, v109, 31, v7
    v_or_b32 v109, 0x18020, v109
    v_and_or_b32 v110, v110, 31, v7
    v_or_b32 v110, 0x18040, v110
    v_and_or_b32 v111, v111, 31, v7
    v_or_b32 v111, 0x18060, v111
    s_waitcnt lgkmcnt(0)
    s_barrier
    v_lshlrev_b32 v5, 5, v240
    ds_read_b128 v[160:163], v5 offset:18432
    ds_read_b128 v[164:167], v5 offset:18448
    ds_read_b64 v[180:181], v2 offset:18432
    s_waitcnt lgkmcnt(1)
    v_mov_b32 v168, 0
    v_mov_b32 v169, v160
    v_add_u32 v170, v169, v161
    v_add_u32 v171, v170, v162
    v_add_u32 v172, v171, v163
    v_add_u32 v173, v172, v164
    v_add_u32 v174, v173, v165
    v_add_u32 v175, v174, v166
    v_add_u32 v6, v175, v167
    v_mov_b32 v7, v6
    s_nop 1
    v_add_u32_dpp v6, v6, v6 row_shr:1 row_mask:0xf bank_mask:0xf bound_ctrl:0
    s_nop 1
    v_add_u32_dpp v6, v6, v6 row_shr:2 row_mask:0xf bank_mask:0xf bound_ctrl:0
    s_nop 1
    v_add_u32_dpp v6, v6, v6 row_shr:4 row_mask:0xf bank_mask:0xf bound_ctrl:0
    s_nop 1
    v_add_u32_dpp v6, v6, v6 row_shr:8 row_mask:0xf bank_mask:0xf bound_ctrl:0
    s_nop 1
    v_add_u32_dpp v6, v6, v6 row_bcast:15 row_mask:0xa bank_mask:0xf
    s_nop 1
    v_add_u32_dpp v6, v6, v6 row_bcast:31 row_mask:0xc bank_mask:0xf
    s_nop 1
    v_sub_u32 v6, v6, v7
    v_add_u32 v168, v168, v6
    v_add_u32 v169, v169, v6
    v_add_u32 v170, v170, v6
    v_add_u32 v171, v171, v6
    v_add_u32 v172, v172, v6
    v_add_u32 v173, v173, v6
    v_add_u32 v174, v174, v6
    v_add_u32 v175, v175, v6
    ds_write_b128 v5, v[168:171] offset:20480
    ds_write_b128 v5, v[172:175] offset:20496
    ds_read_b64 v[182:183], v2 offset:20480
    ds_read_b32 v128, v128 offset:20480
    ds_read_b32 v129, v129 offset:20480
    ds_read_b32 v130, v130 offset:20480
    ds_read_b32 v131, v131 offset:20480
    ds_read_b32 v132, v132 offset:20480
    ds_read_b32 v133, v133 offset:20480
    ds_read_b32 v134, v134 offset:20480
    ds_read_b32 v135, v135 offset:20480
    ds_read_b32 v136, v136 offset:20480
    ds_read_b32 v137, v137 offset:20480
    ds_read_b32 v138, v138 offset:20480
    ds_read_b32 v139, v139 offset:20480
    ds_read_b32 v140, v140 offset:20480
    ds_read_b32 v141, v141 offset:20480
    ds_read_b32 v142, v142 offset:20480
    ds_read_b32 v143, v143 offset:20480
    s_waitcnt vmcnt(4) lgkmcnt(12)
    s_mov_b64 exec, s[8:9]
    v_lshl_or_b32 v96, v112, 17, v96
    v_add_lshl_u32 v128, v128, v144, 2
    ds_write_b32 v128, v96 offset:22528
    v_lshl_or_b32 v97, v113, 17, v97
    v_add_lshl_u32 v129, v129, v145, 2
    ds_write_b32 v129, v97 offset:22528
    v_lshl_or_b32 v98, v114, 17, v98
    v_add_lshl_u32 v130, v130, v146, 2
    ds_write_b32 v130, v98 offset:22528
    v_lshl_or_b32 v99, v115, 17, v99
    v_add_lshl_u32 v131, v131, v147, 2
    ds_write_b32 v131, v99 offset:22528
    s_waitcnt vmcnt(3) lgkmcnt(12)
    s_mov_b64 exec, s[10:11]
    v_lshl_or_b32 v100, v116, 17, v100
    v_add_lshl_u32 v132, v132, v148, 2
    ds_write_b32 v132, v100 offset:22528
    v_lshl_or_b32 v101, v117, 17, v101
    v_add_lshl_u32 v133, v133, v149, 2
    ds_write_b32 v133, v101 offset:22528
    v_lshl_or_b32 v102, v118, 17, v102
    v_add_lshl_u32 v134, v134, v150, 2
    ds_write_b32 v134, v102 offset:22528
    v_lshl_or_b32 v103, v119, 17, v103
    v_add_lshl_u32 v135, v135, v151, 2
    ds_write_b32 v135, v103 offset:22528
    s_waitcnt vmcnt(2) lgkmcnt(12)
    s_mov_b64 exec, s[12:13]
    v_lshl_or_b32 v104, v120, 17, v104
    v_add_lshl_u32 v136, v136, v152, 2
    ds_write_b32 v136, v104 offset:22528
    v_lshl_or_b32 v105, v121, 17, v105
    v_add_lshl_u32 v137, v137, v153, 2
    ds_write_b32 v137, v105 offset:22528
    v_lshl_or_b32 v106, v122, 17, v106
    v_add_lshl_u32 v138, v138, v154, 2
    ds_write_b32 v138, v106 offset:22528
    v_lshl_or_b32 v107, v123, 17, v107
    v_add_lshl_u32 v139, v139, v155, 2
    ds_write_b32 v139, v107 offset:22528
    s_waitcnt vmcnt(1) lgkmcnt(12)
    s_mov_b64 exec, s[14:15]
    v_lshl_or_b32 v108, v124, 17, v108
    v_add_lshl_u32 v140, v140, v156, 2
    ds_write_b32 v140, v108 offset:22528
    v_lshl_or_b32 v109, v125, 17, v109
    v_add_lshl_u32 v141, v141, v157, 2
    ds_write_b32 v141, v109 offset:22528
    v_lshl_or_b32 v110, v126, 17, v110
    v_add_lshl_u32 v142, v142, v158, 2
    ds_write_b32 v142, v110 offset:22528
    v_lshl_or_b32 v111, v127, 17, v111
    v_add_lshl_u32 v143, v143, v159, 2
    ds_write_b32 v143, v111 offset:22528
    s_mov_b64 exec, -1
    s_waitcnt vmcnt(0) lgkmcnt(0)
    s_barrier
    ds_read_b128 v[96:99], v176 offset:22528
    ds_read_b128 v[100:103], v176 offset:26624
    ds_read_b128 v[104:107], v176 offset:30720
    ds_read_b128 v[108:111], v176 offset:34816
    s_add_u32 s91, s90, 0
    s_waitcnt lgkmcnt(3)
    buffer_store_dwordx4 v[96:99], v176, s[20:23], s91 offen sc1
    s_add_u32 s91, s90, 4096
    s_waitcnt lgkmcnt(2)
    buffer_store_dwordx4 v[100:103], v176, s[20:23], s91 offen sc1
    s_add_u32 s91, s90, 8192
    s_waitcnt lgkmcnt(1)
    buffer_store_dwordx4 v[104:107], v176, s[20:23], s91 offen sc1
    s_add_u32 s91, s90, 12288
    s_waitcnt lgkmcnt(0)
    buffer_store_dwordx4 v[108:111], v176, s[20:23], s91 offen sc1
    v_lshl_or_b32 v160, v180, 16, v182
    v_lshl_or_b32 v162, v181, 16, v183
    v_readfirstlane_b32 s59, v177
    s_lshl_b32 s91, s2, 12
    s_add_u32 s91, s91, 0x320000
    s_mov_b64 s[8:9], -1
    s_branch F_QW
F_NOTSORT:
    s_cmp_ge_u32 s76, 245
    s_cbranch_scc1 F_NOTP
    s_add_u32 s8, s68, 0x420000
    s_addc_u32 s9, s69, 0
    s_and_b32 s9, s9, 0xffff
    s_mov_b32 s10, 0x186a00
    s_mov_b32 s11, 0x20000
    s_lshl_b32 s91, s91, 7
    s_waitcnt vmcnt(0)
    s_barrier
    ds_read_b128 v[80:83], v229 offset:0
    ds_read_b128 v[84:87], v230 offset:0
    ds_read_b128 v[88:91], v231 offset:0
    ds_read_b128 v[92:95], v232 offset:0
    ds_read_b128 v[96:99], v229 offset:4096
    ds_read_b128 v[100:103], v230 offset:4096
    ds_read_b128 v[104:107], v231 offset:4096
    ds_read_b128 v[108:111], v232 offset:4096
    ds_read_b64_tr_b16 v[144:145], v252 offset:18432
    ds_read_b64_tr_b16 v[146:147], v252 offset:18944
    ds_read_b64_tr_b16 v[148:149], v252 offset:18496
    ds_read_b64_tr_b16 v[150:151], v252 offset:19008
    ds_read_b64_tr_b16 v[152:153], v252 offset:20480
    ds_read_b64_tr_b16 v[154:155], v252 offset:20992
    ds_read_b64_tr_b16 v[156:157], v252 offset:20544
    ds_read_b64_tr_b16 v[158:159], v252 offset:21056
    ds_read_b64_tr_b16 v[160:161], v252 offset:22528
    ds_read_b64_tr_b16 v[162:163], v252 offset:23040
    ds_read_b64_tr_b16 v[164:165], v252 offset:22592
    ds_read_b64_tr_b16 v[166:167], v252 offset:23104
    ds_read_b64_tr_b16 v[168:169], v252 offset:24576
    ds_read_b64_tr_b16 v[170:171], v252 offset:25088
    ds_read_b64_tr_b16 v[172:173], v252 offset:24640
    ds_read_b64_tr_b16 v[174:175], v252 offset:25152
    buffer_load_dword v177, v239, s[60:63], 0 offen sc1
    s_mov_b32 s14, 0x3fb8aa3b
    v_and_b32 v5, 0x38, v240
    v_lshlrev_b32 v5, 4, v5
    v_add_u32 v6, v213, v5
    v_add_u32 v7, v215, v5
    v_add_u32 v5, s45, v3
    s_add_u32 s13, s91, 4096
    s_waitcnt lgkmcnt(0)
    v_mfma_f32_32x32x16_bf16 v[112:127], v[144:147], v[80:83], 0
    v_mfma_f32_32x32x16_bf16 v[112:127], v[152:155], v[84:87], v[112:127]
    v_mfma_f32_32x32x16_bf16 v[112:127], v[160:163], v[88:91], v[112:127]
    v_mfma_f32_32x32x16_bf16 v[112:127], v[168:171], v[92:95], v[112:127]
    v_mfma_f32_32x32x16_bf16 v[128:143], v[148:151], v[80:83], 0
    v_mfma_f32_32x32x16_bf16 v[128:143], v[156:159], v[84:87], v[128:143]
    v_mfma_f32_32x32x16_bf16 v[128:143], v[164:167], v[88:91], v[128:143]
    v_mfma_f32_32x32x16_bf16 v[128:143], v[172:175], v[92:95], v[128:143]
    v_mfma_f32_32x32x16_bf16 v[48:63], v[144:147], v[96:99], 0
    v_mfma_f32_32x32x16_bf16 v[48:63], v[152:155], v[100:103], v[48:63]
    v_mfma_f32_32x32x16_bf16 v[48:63], v[160:163], v[104:107], v[48:63]
    v_mfma_f32_32x32x16_bf16 v[48:63], v[168:171], v[108:111], v[48:63]
    v_mfma_f32_32x32x16_bf16 v[64:79], v[148:151], v[96:99], 0
    v_mfma_f32_32x32x16_bf16 v[64:79], v[156:159], v[100:103], v[64:79]
    v_mfma_f32_32x32x16_bf16 v[64:79], v[164:167], v[104:107], v[64:79]
    v_mfma_f32_32x32x16_bf16 v[64:79], v[172:175], v[108:111], v[64:79]
    v_mul_f32 v112, s14, v112
    v_mul_f32 v113, s14, v113
    v_mul_f32 v114, s14, v114
    v_mul_f32 v115, s14, v115
    v_mul_f32 v116, s14, v116
    v_mul_f32 v117, s14, v117
    v_mul_f32 v118, s14, v118
    v_mul_f32 v119, s14, v119
    v_mul_f32 v120, s14, v120
    v_mul_f32 v121, s14, v121
    v_mul_f32 v122, s14, v122
    v_mul_f32 v123, s14, v123
    v_mul_f32 v124, s14, v124
    v_mul_f32 v125, s14, v125
    v_mul_f32 v126, s14, v126
    v_mul_f32 v127, s14, v127
    v_cvt_pk_bf16_f32 v112, v112, v113
    v_cvt_pk_bf16_f32 v113, v114, v115
    v_cvt_pk_bf16_f32 v114, v116, v117
    v_cvt_pk_bf16_f32 v115, v118, v119
    v_cvt_pk_bf16_f32 v116, v120, v121
    v_cvt_pk_bf16_f32 v117, v122, v123
    v_cvt_pk_bf16_f32 v118, v124, v125
    v_cvt_pk_bf16_f32 v119, v126, v127
    ds_write_b128 v229, v[112:115]
    ds_write_b128 v230, v[116:119]
    v_mul_f32 v128, s14, v128
    v_mul_f32 v129, s14, v129
    v_mul_f32 v130, s14, v130
    v_mul_f32 v131, s14, v131
    v_mul_f32 v132, s14, v132
    v_mul_f32 v133, s14, v133
    v_mul_f32 v134, s14, v134
    v_mul_f32 v135, s14, v135
    v_mul_f32 v136, s14, v136
    v_mul_f32 v137, s14, v137
    v_mul_f32 v138, s14, v138
    v_mul_f32 v139, s14, v139
    v_mul_f32 v140, s14, v140
    v_mul_f32 v141, s14, v141
    v_mul_f32 v142, s14, v142
    v_mul_f32 v143, s14, v143
    v_cvt_pk_bf16_f32 v128, v128, v129
    v_cvt_pk_bf16_f32 v129, v130, v131
    v_cvt_pk_bf16_f32 v130, v132, v133
    v_cvt_pk_bf16_f32 v131, v134, v135
    v_cvt_pk_bf16_f32 v132, v136, v137
    v_cvt_pk_bf16_f32 v133, v138, v139
    v_cvt_pk_bf16_f32 v134, v140, v141
    v_cvt_pk_bf16_f32 v135, v142, v143
    ds_write_b128 v231, v[128:131]
    ds_write_b128 v232, v[132:135]
    ds_read_b128 v[16:19], v5 offset:0
    ds_read_b128 v[20:23], v5 offset:1024
    ds_read_b128 v[24:27], v5 offset:2048
    ds_read_b128 v[28:31], v5 offset:3072
    s_waitcnt lgkmcnt(3)
    buffer_store_dwordx4 v[16:19], v6, s[8:11], s91 offen offset:0 sc1
    s_waitcnt lgkmcnt(2)
    buffer_store_dwordx4 v[20:23], v7, s[8:11], s91 offen offset:1024 sc1
    s_waitcnt lgkmcnt(1)
    buffer_store_dwordx4 v[24:27], v6, s[8:11], s91 offen offset:2048 sc1
    s_waitcnt lgkmcnt(0)
    buffer_store_dwordx4 v[28:31], v7, s[8:11], s91 offen offset:3072 sc1
    v_mul_f32 v48, s14, v48
    v_mul_f32 v49, s14, v49
    v_mul_f32 v50, s14, v50
    v_mul_f32 v51, s14, v51
    v_mul_f32 v52, s14, v52
    v_mul_f32 v53, s14, v53
    v_mul_f32 v54, s14, v54
    v_mul_f32 v55, s14, v55
    v_mul_f32 v56, s14, v56
    v_mul_f32 v57, s14, v57
    v_mul_f32 v58, s14, v58
    v_mul_f32 v59, s14, v59
    v_mul_f32 v60, s14, v60
    v_mul_f32 v61, s14, v61
    v_mul_f32 v62, s14, v62
    v_mul_f32 v63, s14, v63
    v_cvt_pk_bf16_f32 v48, v48, v49
    v_cvt_pk_bf16_f32 v49, v50, v51
    v_cvt_pk_bf16_f32 v50, v52, v53
    v_cvt_pk_bf16_f32 v51, v54, v55
    v_cvt_pk_bf16_f32 v52, v56, v57
    v_cvt_pk_bf16_f32 v53, v58, v59
    v_cvt_pk_bf16_f32 v54, v60, v61
    v_cvt_pk_bf16_f32 v55, v62, v63
    ds_write_b128 v229, v[48:51]
    ds_write_b128 v230, v[52:55]
    v_mul_f32 v64, s14, v64
    v_mul_f32 v65, s14, v65
    v_mul_f32 v66, s14, v66
    v_mul_f32 v67, s14, v67
    v_mul_f32 v68, s14, v68
    v_mul_f32 v69, s14, v69
    v_mul_f32 v70, s14, v70
    v_mul_f32 v71, s14, v71
    v_mul_f32 v72, s14, v72
    v_mul_f32 v73, s14, v73
    v_mul_f32 v74, s14, v74
    v_mul_f32 v75, s14, v75
    v_mul_f32 v76, s14, v76
    v_mul_f32 v77, s14, v77
    v_mul_f32 v78, s14, v78
    v_mul_f32 v79, s14, v79
    v_cvt_pk_bf16_f32 v64, v64, v65
    v_cvt_pk_bf16_f32 v65, v66, v67
    v_cvt_pk_bf16_f32 v66, v68, v69
    v_cvt_pk_bf16_f32 v67, v70, v71
    v_cvt_pk_bf16_f32 v68, v72, v73
    v_cvt_pk_bf16_f32 v69, v74, v75
    v_cvt_pk_bf16_f32 v70, v76, v77
    v_cvt_pk_bf16_f32 v71, v78, v79
    ds_write_b128 v231, v[64:67]
    ds_write_b128 v232, v[68:71]
    ds_read_b128 v[32:35], v5 offset:0
    ds_read_b128 v[36:39], v5 offset:1024
    ds_read_b128 v[40:43], v5 offset:2048
    ds_read_b128 v[44:47], v5 offset:3072
    s_waitcnt lgkmcnt(3)
    buffer_store_dwordx4 v[32:35], v6, s[8:11], s13 offen offset:0 sc1
    s_waitcnt lgkmcnt(2)
    buffer_store_dwordx4 v[36:39], v7, s[8:11], s13 offen offset:1024 sc1
    s_waitcnt lgkmcnt(1)
    buffer_store_dwordx4 v[40:43], v6, s[8:11], s13 offen offset:2048 sc1
    s_waitcnt lgkmcnt(0)
    buffer_store_dwordx4 v[44:47], v7, s[8:11], s13 offen offset:3072 sc1
    s_waitcnt vmcnt(8)
    v_readfirstlane_b32 s59, v177
    s_branch F_FLG
F_NOTP:
    s_cmp_eq_u32 s76, 245
    s_cbranch_scc0 F_IDLE
    s_mov_b32 s8, s14
    s_and_b32 s9, s15, 0xffff
    s_mov_b32 s10, 0x4000
    s_mov_b32 s11, 0x20000
    s_lshl_b32 s4, s3, 11
    v_lshlrev_b32 v1, 1, v242
    v_add_u32 v1, s4, v1
    v_lshl_add_u32 v4, v241, 10, v1
    v_add_u32 v5, 512, v4
    buffer_load_ushort v96, v4, s[8:11], 0 offen offset:0
    buffer_load_ushort v97, v4, s[8:11], 0 offen offset:128
    buffer_load_ushort v98, v4, s[8:11], 0 offen offset:256
    buffer_load_ushort v99, v4, s[8:11], 0 offen offset:384
    buffer_load_ushort v100, v5, s[8:11], 0 offen offset:0
    buffer_load_ushort v101, v5, s[8:11], 0 offen offset:128
    buffer_load_ushort v102, v5, s[8:11], 0 offen offset:256
    buffer_load_ushort v103, v5, s[8:11], 0 offen offset:384
    buffer_load_ushort v104, v4, s[8:11], 0 offen offset:64
    buffer_load_ushort v105, v4, s[8:11], 0 offen offset:192
    buffer_load_ushort v106, v4, s[8:11], 0 offen offset:320
    buffer_load_ushort v107, v4, s[8:11], 0 offen offset:448
    buffer_load_ushort v108, v5, s[8:11], 0 offen offset:64
    buffer_load_ushort v109, v5, s[8:11], 0 offen offset:192
    buffer_load_ushort v110, v5, s[8:11], 0 offen offset:320
    buffer_load_ushort v111, v5, s[8:11], 0 offen offset:448
    v_lshl_add_u32 v6, v241, 9, v1
    v_add_u32 v6, 0x2000, v6
    v_add_u32 v7, 1024, v6
    buffer_load_ushort v112, v6, s[8:11], 0 offen offset:0
    buffer_load_ushort v113, v6, s[8:11], 0 offen offset:128
    buffer_load_ushort v114, v6, s[8:11], 0 offen offset:256
    buffer_load_ushort v115, v6, s[8:11], 0 offen offset:384
    buffer_load_ushort v116, v7, s[8:11], 0 offen offset:0
    buffer_load_ushort v117, v7, s[8:11], 0 offen offset:128
    buffer_load_ushort v118, v7, s[8:11], 0 offen offset:256
    buffer_load_ushort v119, v7, s[8:11], 0 offen offset:384
    buffer_load_ushort v120, v6, s[8:11], 0 offen offset:64
    buffer_load_ushort v121, v6, s[8:11], 0 offen offset:192
    buffer_load_ushort v122, v6, s[8:11], 0 offen offset:320
    buffer_load_ushort v123, v6, s[8:11], 0 offen offset:448
    buffer_load_ushort v124, v7, s[8:11], 0 offen offset:64
    buffer_load_ushort v125, v7, s[8:11], 0 offen offset:192
    buffer_load_ushort v126, v7, s[8:11], 0 offen offset:320
    buffer_load_ushort v127, v7, s[8:11], 0 offen offset:448
    s_lshl_b32 s12, s3, 10
    s_add_u32 s12, s12, 0x5b0000
    s_add_u32 s13, s12, 8192
    s_add_u32 s14, s12, 4096
    s_add_u32 s15, s12, 12288
    s_mov_b32 s90, 49
    s_waitcnt vmcnt(0)
    v_lshl_or_b32 v144, v97, 16, v96
    v_lshl_or_b32 v145, v99, 16, v98
    v_lshl_or_b32 v146, v101, 16, v100
    v_lshl_or_b32 v147, v103, 16, v102
    v_lshl_or_b32 v148, v105, 16, v104
    v_lshl_or_b32 v149, v107, 16, v106
    v_lshl_or_b32 v150, v109, 16, v108
    v_lshl_or_b32 v151, v111, 16, v110
    v_lshl_or_b32 v152, v113, 16, v112
    v_lshl_or_b32 v153, v115, 16, v114
    v_lshl_or_b32 v154, v117, 16, v116
    v_lshl_or_b32 v155, v119, 16, v118
    v_lshl_or_b32 v156, v121, 16, v120
    v_lshl_or_b32 v157, v123, 16, v122
    v_lshl_or_b32 v158, v125, 16, v124
    v_lshl_or_b32 v159, v127, 16, v126
    buffer_store_dwordx4 v[144:147], v3, s[20:23], s12 offen sc1
    buffer_store_dwordx4 v[148:151], v3, s[20:23], s13 offen sc1
    buffer_store_dwordx4 v[152:155], v3, s[20:23], s14 offen sc1
    buffer_store_dwordx4 v[156:159], v3, s[20:23], s15 offen sc1
F_FLG:
    s_lshl_b32 s91, s90, 4
    s_add_u32 s91, s91, 0x5b8000
    s_cmp_eq_u32 s3, 0
    s_cselect_b64 s[8:9], 1, 0
    s_branch F_QW
F_IDLE:
    s_mov_b64 s[8:9], 0
    s_mov_b32 s91, 0
F_QW:
    s_cmp_lg_u32 s59, 0
    s_cbranch_scc1 F_HT
    s_mov_b32 s19, 0x40000
F_TG1:
    buffer_load_dword v1, v239, s[60:63], 0 offen sc1
    s_sub_u32 s19, s19, 1
    s_waitcnt vmcnt(0)
    v_readfirstlane_b32 s59, v1
    s_cmp_eq_u32 s19, 0
    s_cbranch_scc1 F_TD2
    s_cmp_eq_u32 s59, 0
    s_cbranch_scc1 F_TG1
F_TD2:
F_HT:
    v_mov_b32 v161, s59
    v_mov_b32 v163, s59
    s_waitcnt vmcnt(0) lgkmcnt(0)
    s_barrier
    s_mov_b64 exec, s[8:9]
    s_cbranch_execz F_NS
    buffer_store_dwordx4 v[160:163], v176, s[20:23], s91 offen sc1
F_NS:
    s_mov_b64 exec, -1
    s_lshl_b32 s4, s3, 10
    s_add_u32 s4, s4, 0
    s_add_u32 m0, s4, 8192
    s_add_u32 s4, s4, 8192
    buffer_load_dwordx4 v3, s[64:67], s4 offen lds
    s_lshl_b32 s4, s3, 10
    s_add_u32 s4, s4, 4096
    s_add_u32 m0, s4, 8192
    s_add_u32 s4, s4, 8192
    buffer_load_dwordx4 v3, s[64:67], s4 offen lds
    s_and_b32 s4, s3, 1
    s_lshl_b32 s4, s4, 10
    s_add_u32 s4, s4, 8192
    s_add_u32 m0, s4, 8192
    s_add_u32 s4, s4, 8192
    buffer_load_dwordx4 v3, s[64:67], s4 offen lds
    v_lshrrev_b32 v1, 3, v240
    v_subrev_u32 v1, s40, v1
    v_add_u32 v212, 0, v1
    v_and_b32 v212, 31, v212
    v_add_u32 v212, s40, v212
    s_add_u32 m0, s45, 4096
    v_min_u32 v212, 12499, v212
    buffer_load_dwordx4 v[212:213], s[84:87], 0 idxen offen lds
    v_add_u32 v214, 8, v1
    v_and_b32 v214, 31, v214
    v_add_u32 v214, s40, v214
    s_add_u32 m0, s45, 5120
    v_min_u32 v214, 12499, v214
    buffer_load_dwordx4 v[214:215], s[84:87], 0 idxen offen lds
    v_add_u32 v216, 16, v1
    v_and_b32 v216, 31, v216
    v_add_u32 v216, s40, v216
    s_add_u32 m0, s45, 6144
    v_min_u32 v216, 12499, v216
    buffer_load_dwordx4 v[216:217], s[84:87], 0 idxen offen lds
    v_add_u32 v218, 24, v1
    v_and_b32 v218, 31, v218
    v_add_u32 v218, s40, v218
    s_add_u32 m0, s45, 7168
    v_min_u32 v218, 12499, v218
    buffer_load_dwordx4 v[218:219], s[84:87], 0 idxen offen lds
    v_lshlrev_b32 v180, 4, v0
    v_mov_b32 v184, 0
    v_mov_b32 v188, s48
    v_mov_b32 v185, 0
    v_mov_b32 v189, s48
    v_mov_b32 v186, 0
    v_mov_b32 v190, s48
    v_mov_b32 v187, 0
    v_mov_b32 v191, s48
    ds_write_b128 v180, v[184:187] offset:18432
    ds_write_b128 v180, v[188:191] offset:24064
    ds_write_b128 v180, v[188:191] offset:28160
    v_cmp_gt_u32 vcc, 192, v0
    s_mov_b64 exec, vcc
    ds_write_b128 v180, v[188:191] offset:32256
    v_cmp_gt_u32 vcc, 96, v0
    s_mov_b64 exec, vcc
    ds_write_b128 v180, v[184:187] offset:22528
    s_mov_b64 exec, -1
    v_add_u32 v5, s77, v3
    v_lshl_add_u32 v6, v240, 3, s77
    ds_write_b128 v5, v[184:187]
    ds_write_b128 v5, v[184:187] offset:1024
    ds_write_b64 v6, v[184:185] offset:2048
    ds_write_b128 v253, v[8:11] offset:35328
    ds_write_b128 v253, v[12:15] offset:35360
    s_waitcnt vmcnt(0)
    s_barrier
    ds_read_b128 v[144:147], v229 offset:4096
    ds_read_b128 v[148:151], v230 offset:4096
    ds_read_b128 v[152:155], v231 offset:4096
    ds_read_b128 v[156:159], v232 offset:4096
    ds_read_b64_tr_b16 v[48:49], v252 offset:8192
    ds_read_b64_tr_b16 v[50:51], v252 offset:8704
    ds_read_b64_tr_b16 v[52:53], v252 offset:8256
    ds_read_b64_tr_b16 v[54:55], v252 offset:8768
    ds_read_b64_tr_b16 v[56:57], v252 offset:10240
    ds_read_b64_tr_b16 v[58:59], v252 offset:10752
    ds_read_b64_tr_b16 v[60:61], v252 offset:10304
    ds_read_b64_tr_b16 v[62:63], v252 offset:10816
    ds_read_b64_tr_b16 v[64:65], v252 offset:12288
    ds_read_b64_tr_b16 v[66:67], v252 offset:12800
    ds_read_b64_tr_b16 v[68:69], v252 offset:12352
    ds_read_b64_tr_b16 v[70:71], v252 offset:12864
    ds_read_b64_tr_b16 v[72:73], v252 offset:14336
    ds_read_b64_tr_b16 v[74:75], v252 offset:14848
    ds_read_b64_tr_b16 v[76:77], v252 offset:14400
    ds_read_b64_tr_b16 v[78:79], v252 offset:14912
    ds_read_b64_tr_b16 v[196:197], v252 offset:16384
    ds_read_b64_tr_b16 v[198:199], v252 offset:16896
    ds_read_b64_tr_b16 v[200:201], v252 offset:16448
    ds_read_b64_tr_b16 v[202:203], v252 offset:16960
    s_mov_b32 s14, 0x3fb8aa3b
    s_waitcnt lgkmcnt(4)
    v_mfma_f32_32x32x16_bf16 v[112:127], v[144:147], v[48:51], 0
    v_mfma_f32_32x32x16_bf16 v[112:127], v[148:151], v[56:59], v[112:127]
    v_mfma_f32_32x32x16_bf16 v[112:127], v[152:155], v[64:67], v[112:127]
    v_mfma_f32_32x32x16_bf16 v[112:127], v[156:159], v[72:75], v[112:127]
    v_mfma_f32_32x32x16_bf16 v[128:143], v[144:147], v[52:55], 0
    v_mfma_f32_32x32x16_bf16 v[128:143], v[148:151], v[60:63], v[128:143]
    v_mfma_f32_32x32x16_bf16 v[128:143], v[152:155], v[68:71], v[128:143]
    v_mfma_f32_32x32x16_bf16 v[128:143], v[156:159], v[76:79], v[128:143]
    s_waitcnt lgkmcnt(0)
    v_lshlrev_b32 v160, 16, v196
    v_and_b32 v161, 0xffff0000, v196
    v_lshlrev_b32 v162, 16, v197
    v_and_b32 v163, 0xffff0000, v197
    v_lshlrev_b32 v164, 16, v198
    v_and_b32 v165, 0xffff0000, v198
    v_lshlrev_b32 v166, 16, v199
    v_and_b32 v167, 0xffff0000, v199
    v_lshlrev_b32 v168, 16, v200
    v_and_b32 v169, 0xffff0000, v200
    v_lshlrev_b32 v170, 16, v201
    v_and_b32 v171, 0xffff0000, v201
    v_lshlrev_b32 v172, 16, v202
    v_and_b32 v173, 0xffff0000, v202
    v_lshlrev_b32 v174, 16, v203
    v_and_b32 v175, 0xffff0000, v203
    v_mul_f32 v4, s14, v160
    v_mul_f32 v5, s14, v161
    v_cvt_pk_bf16_f32 v16, v4, v5
    v_mul_f32 v4, s14, v162
    v_mul_f32 v5, s14, v163
    v_cvt_pk_bf16_f32 v17, v4, v5
    v_mul_f32 v4, s14, v164
    v_mul_f32 v5, s14, v165
    v_cvt_pk_bf16_f32 v18, v4, v5
    v_mul_f32 v4, s14, v166
    v_mul_f32 v5, s14, v167
    v_cvt_pk_bf16_f32 v19, v4, v5
    v_mul_f32 v4, s14, v168
    v_mul_f32 v5, s14, v169
    v_cvt_pk_bf16_f32 v20, v4, v5
    v_mul_f32 v4, s14, v170
    v_mul_f32 v5, s14, v171
    v_cvt_pk_bf16_f32 v21, v4, v5
    v_mul_f32 v4, s14, v172
    v_mul_f32 v5, s14, v173
    v_cvt_pk_bf16_f32 v22, v4, v5
    v_mul_f32 v4, s14, v174
    v_mul_f32 v5, s14, v175
    v_cvt_pk_bf16_f32 v23, v4, v5
    v_lshlrev_b32 v4, 16, v16
    v_and_b32 v5, 0xffff0000, v16
    v_fma_f32 v4, v160, s14, -v4
    v_fma_f32 v5, v161, s14, -v5
    v_cvt_pk_bf16_f32 v24, v4, v5
    v_lshlrev_b32 v4, 16, v17
    v_and_b32 v5, 0xffff0000, v17
    v_fma_f32 v4, v162, s14, -v4
    v_fma_f32 v5, v163, s14, -v5
    v_cvt_pk_bf16_f32 v25, v4, v5
    v_lshlrev_b32 v4, 16, v18
    v_and_b32 v5, 0xffff0000, v18
    v_fma_f32 v4, v164, s14, -v4
    v_fma_f32 v5, v165, s14, -v5
    v_cvt_pk_bf16_f32 v26, v4, v5
    v_lshlrev_b32 v4, 16, v19
    v_and_b32 v5, 0xffff0000, v19
    v_fma_f32 v4, v166, s14, -v4
    v_fma_f32 v5, v167, s14, -v5
    v_cvt_pk_bf16_f32 v27, v4, v5
    v_lshlrev_b32 v4, 16, v20
    v_and_b32 v5, 0xffff0000, v20
    v_fma_f32 v4, v168, s14, -v4
    v_fma_f32 v5, v169, s14, -v5
    v_cvt_pk_bf16_f32 v28, v4, v5
    v_lshlrev_b32 v4, 16, v21
    v_and_b32 v5, 0xffff0000, v21
    v_fma_f32 v4, v170, s14, -v4
    v_fma_f32 v5, v171, s14, -v5
    v_cvt_pk_bf16_f32 v29, v4, v5
    v_lshlrev_b32 v4, 16, v22
    v_and_b32 v5, 0xffff0000, v22
    v_fma_f32 v4, v172, s14, -v4
    v_fma_f32 v5, v173, s14, -v5
    v_cvt_pk_bf16_f32 v30, v4, v5
    v_lshlrev_b32 v4, 16, v23
    v_and_b32 v5, 0xffff0000, v23
    v_fma_f32 v4, v174, s14, -v4
    v_fma_f32 v5, v175, s14, -v5
    v_cvt_pk_bf16_f32 v31, v4, v5
    v_mul_f32 v112, s14, v112
    v_mul_f32 v113, s14, v113
    v_mul_f32 v114, s14, v114
    v_mul_f32 v115, s14, v115
    v_mul_f32 v116, s14, v116
    v_mul_f32 v117, s14, v117
    v_mul_f32 v118, s14, v118
    v_mul_f32 v119, s14, v119
    v_mul_f32 v120, s14, v120
    v_mul_f32 v121, s14, v121
    v_mul_f32 v122, s14, v122
    v_mul_f32 v123, s14, v123
    v_mul_f32 v124, s14, v124
    v_mul_f32 v125, s14, v125
    v_mul_f32 v126, s14, v126
    v_mul_f32 v127, s14, v127
    v_cvt_pk_bf16_f32 v32, v112, v113
    v_cvt_pk_bf16_f32 v33, v114, v115
    v_cvt_pk_bf16_f32 v34, v116, v117
    v_cvt_pk_bf16_f32 v35, v118, v119
    v_cvt_pk_bf16_f32 v40, v120, v121
    v_cvt_pk_bf16_f32 v41, v122, v123
    v_cvt_pk_bf16_f32 v42, v124, v125
    v_cvt_pk_bf16_f32 v43, v126, v127
    v_mul_f32 v128, s14, v128
    v_mul_f32 v129, s14, v129
    v_mul_f32 v130, s14, v130
    v_mul_f32 v131, s14, v131
    v_mul_f32 v132, s14, v132
    v_mul_f32 v133, s14, v133
    v_mul_f32 v134, s14, v134
    v_mul_f32 v135, s14, v135
    v_mul_f32 v136, s14, v136
    v_mul_f32 v137, s14, v137
    v_mul_f32 v138, s14, v138
    v_mul_f32 v139, s14, v139
    v_mul_f32 v140, s14, v140
    v_mul_f32 v141, s14, v141
    v_mul_f32 v142, s14, v142
    v_mul_f32 v143, s14, v143
    v_cvt_pk_bf16_f32 v36, v128, v129
    v_cvt_pk_bf16_f32 v37, v130, v131
    v_cvt_pk_bf16_f32 v38, v132, v133
    v_cvt_pk_bf16_f32 v39, v134, v135
    v_cvt_pk_bf16_f32 v44, v136, v137
    v_cvt_pk_bf16_f32 v45, v138, v139
    v_cvt_pk_bf16_f32 v46, v140, v141
    v_cvt_pk_bf16_f32 v47, v142, v143
    v_mov_b32 v48, 0
    v_mov_b32 v49, 0
    v_mov_b32 v50, 0
    v_mov_b32 v51, 0
    v_mov_b32 v52, 0
    v_mov_b32 v53, 0
    v_mov_b32 v54, 0
    v_mov_b32 v55, 0
    v_mov_b32 v56, 0
    v_mov_b32 v57, 0
    v_mov_b32 v58, 0
    v_mov_b32 v59, 0
    v_mov_b32 v60, 0
    v_mov_b32 v61, 0
    v_mov_b32 v62, 0
    v_mov_b32 v63, 0
    v_mov_b32 v64, 0
    v_mov_b32 v65, 0
    v_mov_b32 v66, 0
    v_mov_b32 v67, 0
    v_mov_b32 v68, 0
    v_mov_b32 v69, 0
    v_mov_b32 v70, 0
    v_mov_b32 v71, 0
    v_mov_b32 v72, 0
    v_mov_b32 v73, 0
    v_mov_b32 v74, 0
    v_mov_b32 v75, 0
    v_mov_b32 v76, 0
    v_mov_b32 v77, 0
    v_mov_b32 v78, 0
    v_mov_b32 v79, 0
    v_lshrrev_b32 v2, 5, v247
    s_lshl_b32 s12, s56, 3
    s_add_u32 s12, s12, 0x320000
    v_cmp_gt_u32 vcc, 49, v240
    s_mov_b64 s[16:17], vcc
    s_mov_b32 s13, 0x40000
    s_cmp_lt_u32 s76, 245
    s_cbranch_scc1 F_GOT1
    s_mov_b64 exec, 15
F_POLL1:
    buffer_load_dwordx2 v[4:5], v2, s[20:23], s12 offen sc1
    s_sub_u32 s13, s13, 1
    s_waitcnt vmcnt(0)
    v_cmp_ne_u32 vcc, s59, v5
    s_cmp_eq_u32 s13, 1
    s_cbranch_scc1 F_GOT1
    s_cbranch_vccz F_GOT1
    s_sleep 4
    s_branch F_POLL1
F_GOT1:
    s_mov_b32 s15, 0xe000e000
    s_mov_b64 exec, s[16:17]
F_POLL:
    buffer_load_dwordx2 v[4:5], v2, s[20:23], s12 offen sc1
    s_sub_u32 s13, s13, 1
    s_waitcnt vmcnt(0)
    v_xor_b32 v6, s59, v5
    v_and_or_b32 v6, v4, s15, v6
    v_cmpx_ne_u32 vcc, 0, v6
    s_cmp_eq_u32 s13, 0
    s_cbranch_scc1 F_GOT
    s_cbranch_execz F_GOT
    s_sleep 4
    s_branch F_POLL
F_GOT:
    s_mov_b64 exec, -1
    s_mov_b64 vcc, s[16:17]
    v_cndmask_b32 v4, 0, v4, vcc
    v_lshrrev_b32 v244, 16, v4
    v_and_b32 v4, 0xffff, v4
    v_lshl_add_u32 v243, v4, 2, v243
    v_lshl_add_u32 v180, v246, 2, v243
    v_sub_u32 v181, v244, v246
    v_cmpx_lt_i32 vcc, 0, v181
    s_cbranch_execz K2_RL0
    buffer_load_dwordx4 v[80:83], v180, s[20:23], 0 offen offset:0 sc1
    v_cmpx_lt_i32 vcc, 4, v181
    s_cbranch_execz K2_RL0
    buffer_load_dwordx4 v[84:87], v180, s[20:23], 0 offen offset:16 sc1
    v_cmpx_lt_i32 vcc, 8, v181
    s_cbranch_execz K2_RL0
    buffer_load_dwordx4 v[88:91], v180, s[20:23], 0 offen offset:32 sc1
    v_cmpx_lt_i32 vcc, 12, v181
    s_cbranch_execz K2_RL0
    buffer_load_dwordx4 v[92:95], v180, s[20:23], 0 offen offset:48 sc1
    v_cmpx_lt_i32 vcc, 16, v181
    s_cbranch_execz K2_RL0
    buffer_load_dwordx4 v[96:99], v180, s[20:23], 0 offen offset:64 sc1
    v_cmpx_lt_i32 vcc, 20, v181
    s_cbranch_execz K2_RL0
    buffer_load_dwordx4 v[100:103], v180, s[20:23], 0 offen offset:80 sc1
K2_RL0:
    s_mov_b64 exec, -1
    s_mov_b32 s12, 0x5b8000
    buffer_load_dword v255, v3, s[20:23], s12 offen offset:4 sc1
    v_mov_b32 v245, v244
    s_nop 1
    v_add_u32_dpp v245, v245, v245 row_shr:1 row_mask:0xf bank_mask:0xf bound_ctrl:0
    s_nop 1
    v_add_u32_dpp v245, v245, v245 row_shr:2 row_mask:0xf bank_mask:0xf bound_ctrl:0
    s_nop 1
    v_add_u32_dpp v245, v245, v245 row_shr:4 row_mask:0xf bank_mask:0xf bound_ctrl:0
    s_nop 1
    v_add_u32_dpp v245, v245, v245 row_shr:8 row_mask:0xf bank_mask:0xf bound_ctrl:0
    s_nop 1
    v_add_u32_dpp v245, v245, v245 row_bcast:15 row_mask:0xa bank_mask:0xf
    s_nop 1
    v_add_u32_dpp v245, v245, v245 row_bcast:31 row_mask:0xc bank_mask:0xf
    s_nop 1
    v_readlane_b32 s52, v245, 63
    v_sub_u32 v245, v245, v244
    s_lshl_b32 s53, s3, 2
    s_getreg_b32 s11, hwreg(HW_REG_HW_ID, 4, 2)
    s_lshl_b32 s10, 0x1000000, s11
    s_or_b32 s52, s52, s10
    v_mov_b32 v1, s52
    v_mov_b32 v4, s53
    ds_write_b32 v4, v1 offset:48128
    s_waitcnt lgkmcnt(0)
    s_barrier
    ds_read_b128 v[4:7], v239 offset:48128
    s_waitcnt lgkmcnt(0)
    v_readfirstlane_b32 s4, v4
    v_readfirstlane_b32 s5, v5
    v_readfirstlane_b32 s6, v6
    v_readfirstlane_b32 s7, v7
    s_nop 1
    s_mov_b32 s57, s3
    s_or_b32 s8, s4, s5
    s_or_b32 s9, s6, s7
    s_or_b32 s8, s8, s9
    s_lshr_b32 s8, s8, 24
    s_sub_u32 s9, 3, s11
    s_cmp_lt_u32 s2, 256
    s_cselect_b32 s9, s11, s9
    s_cmp_eq_u32 s8, 15
    s_cselect_b32 s57, s9, s57
    s_and_b32 s4, s4, 0xffffff
    s_and_b32 s5, s5, 0xffffff
    s_and_b32 s6, s6, 0xffffff
    s_and_b32 s7, s7, 0xffffff
    s_add_u32 s8, s4, s5
    s_add_u32 s9, s8, s6
    s_add_u32 s42, s9, s7
    s_cmp_eq_u32 s3, 1
    s_cselect_b32 s10, s4, 0
    s_cmp_eq_u32 s3, 2
    s_cselect_b32 s10, s8, s10
    s_cmp_eq_u32 s3, 3
    s_cselect_b32 s10, s9, s10
    v_add_u32 v245, s10, v245
    s_mov_b32 s43, 0
K2_ROUND:
    s_add_u32 s52, s43, 2048
    v_add_u32 v1, v245, v246
    v_sub_u32 v248, s52, v1
    v_sub_u32 v4, v244, v246
    v_min_i32 v248, v248, v4
K2_COPY:
    v_add_u32 v1, v245, v246
    v_subrev_u32 v1, s43, v1
    v_lshlrev_b32 v4, 1, v1
    v_lshlrev_b32 v5, 2, v1
    s_mov_b32 s52, 0x1ffff
    s_waitcnt vmcnt(0)
    v_cmpx_lt_i32 vcc, 0, v248
    s_cbranch_execz K2_CPD
    v_lshrrev_b32 v6, 17, v80
    v_and_or_b32 v7, v80, s52, v247
    ds_write_b16 v4, v6 offset:18432
    ds_write_b32 v5, v7 offset:24064
    v_cmpx_lt_i32 vcc, 1, v248
    v_lshrrev_b32 v6, 17, v81
    v_and_or_b32 v7, v81, s52, v247
    ds_write_b16 v4, v6 offset:18434
    ds_write_b32 v5, v7 offset:24068
    v_cmpx_lt_i32 vcc, 2, v248
    s_cbranch_execz K2_CPD
    v_lshrrev_b32 v6, 17, v82
    v_and_or_b32 v7, v82, s52, v247
    ds_write_b16 v4, v6 offset:18436
    ds_write_b32 v5, v7 offset:24072
    v_cmpx_lt_i32 vcc, 3, v248
    v_lshrrev_b32 v6, 17, v83
    v_and_or_b32 v7, v83, s52, v247
    ds_write_b16 v4, v6 offset:18438
    ds_write_b32 v5, v7 offset:24076
    v_cmpx_lt_i32 vcc, 4, v248
    s_cbranch_execz K2_CPD
    v_lshrrev_b32 v6, 17, v84
    v_and_or_b32 v7, v84, s52, v247
    ds_write_b16 v4, v6 offset:18440
    ds_write_b32 v5, v7 offset:24080
    v_cmpx_lt_i32 vcc, 5, v248
    v_lshrrev_b32 v6, 17, v85
    v_and_or_b32 v7, v85, s52, v247
    ds_write_b16 v4, v6 offset:18442
    ds_write_b32 v5, v7 offset:24084
    v_cmpx_lt_i32 vcc, 6, v248
    s_cbranch_execz K2_CPD
    v_lshrrev_b32 v6, 17, v86
    v_and_or_b32 v7, v86, s52, v247
    ds_write_b16 v4, v6 offset:18444
    ds_write_b32 v5, v7 offset:24088
    v_cmpx_lt_i32 vcc, 7, v248
    v_lshrrev_b32 v6, 17, v87
    v_and_or_b32 v7, v87, s52, v247
    ds_write_b16 v4, v6 offset:18446
    ds_write_b32 v5, v7 offset:24092
    v_cmpx_lt_i32 vcc, 8, v248
    s_cbranch_execz K2_CPD
    v_lshrrev_b32 v6, 17, v88
    v_and_or_b32 v7, v88, s52, v247
    ds_write_b16 v4, v6 offset:18448
    ds_write_b32 v5, v7 offset:24096
    v_cmpx_lt_i32 vcc, 9, v248
    v_lshrrev_b32 v6, 17, v89
    v_and_or_b32 v7, v89, s52, v247
    ds_write_b16 v4, v6 offset:18450
    ds_write_b32 v5, v7 offset:24100
    v_cmpx_lt_i32 vcc, 10, v248
    s_cbranch_execz K2_CPD
    v_lshrrev_b32 v6, 17, v90
    v_and_or_b32 v7, v90, s52, v247
    ds_write_b16 v4, v6 offset:18452
    ds_write_b32 v5, v7 offset:24104
    v_cmpx_lt_i32 vcc, 11, v248
    v_lshrrev_b32 v6, 17, v91
    v_and_or_b32 v7, v91, s52, v247
    ds_write_b16 v4, v6 offset:18454
    ds_write_b32 v5, v7 offset:24108
    v_cmpx_lt_i32 vcc, 12, v248
    s_cbranch_execz K2_CPD
    v_lshrrev_b32 v6, 17, v92
    v_and_or_b32 v7, v92, s52, v247
    ds_write_b16 v4, v6 offset:18456
    ds_write_b32 v5, v7 offset:24112
    v_cmpx_lt_i32 vcc, 13, v248
    v_lshrrev_b32 v6, 17, v93
    v_and_or_b32 v7, v93, s52, v247
    ds_write_b16 v4, v6 offset:18458
    ds_write_b32 v5, v7 offset:24116
    v_cmpx_lt_i32 vcc, 14, v248
    s_cbranch_execz K2_CPD
    v_lshrrev_b32 v6, 17, v94
    v_and_or_b32 v7, v94, s52, v247
    ds_write_b16 v4, v6 offset:18460
    ds_write_b32 v5, v7 offset:24120
    v_cmpx_lt_i32 vcc, 15, v248
    v_lshrrev_b32 v6, 17, v95
    v_and_or_b32 v7, v95, s52, v247
    ds_write_b16 v4, v6 offset:18462
    ds_write_b32 v5, v7 offset:24124
    v_cmpx_lt_i32 vcc, 16, v248
    s_cbranch_execz K2_CPD
    v_lshrrev_b32 v6, 17, v96
    v_and_or_b32 v7, v96, s52, v247
    ds_write_b16 v4, v6 offset:18464
    ds_write_b32 v5, v7 offset:24128
    v_cmpx_lt_i32 vcc, 17, v248
    v_lshrrev_b32 v6, 17, v97
    v_and_or_b32 v7, v97, s52, v247
    ds_write_b16 v4, v6 offset:18466
    ds_write_b32 v5, v7 offset:24132
    v_cmpx_lt_i32 vcc, 18, v248
    s_cbranch_execz K2_CPD
    v_lshrrev_b32 v6, 17, v98
    v_and_or_b32 v7, v98, s52, v247
    ds_write_b16 v4, v6 offset:18468
    ds_write_b32 v5, v7 offset:24136
    v_cmpx_lt_i32 vcc, 19, v248
    v_lshrrev_b32 v6, 17, v99
    v_and_or_b32 v7, v99, s52, v247
    ds_write_b16 v4, v6 offset:18470
    ds_write_b32 v5, v7 offset:24140
    v_cmpx_lt_i32 vcc, 20, v248
    s_cbranch_execz K2_CPD
    v_lshrrev_b32 v6, 17, v100
    v_and_or_b32 v7, v100, s52, v247
    ds_write_b16 v4, v6 offset:18472
    ds_write_b32 v5, v7 offset:24144
    v_cmpx_lt_i32 vcc, 21, v248
    v_lshrrev_b32 v6, 17, v101
    v_and_or_b32 v7, v101, s52, v247
    ds_write_b16 v4, v6 offset:18474
    ds_write_b32 v5, v7 offset:24148
    v_cmpx_lt_i32 vcc, 22, v248
    s_cbranch_execz K2_CPD
    v_lshrrev_b32 v6, 17, v102
    v_and_or_b32 v7, v102, s52, v247
    ds_write_b16 v4, v6 offset:18476
    ds_write_b32 v5, v7 offset:24152
    v_cmpx_lt_i32 vcc, 23, v248
    v_lshrrev_b32 v6, 17, v103
    v_and_or_b32 v7, v103, s52, v247
    ds_write_b16 v4, v6 offset:18478
    ds_write_b32 v5, v7 offset:24156
K2_CPD:
    s_mov_b64 exec, -1
    v_med3_i32 v1, v248, 0, 24
    v_add_u32 v246, v246, v1
    v_subrev_u32 v248, 24, v248
    v_cmp_lt_i32 vcc, 0, v248
    s_cbranch_vccz K2_CPE
    v_lshl_add_u32 v180, v246, 2, v243
    v_sub_u32 v181, v244, v246
    v_cmpx_lt_i32 vcc, 0, v181
    s_cbranch_execz K2_RL1
    buffer_load_dwordx4 v[80:83], v180, s[20:23], 0 offen offset:0 sc1
    v_cmpx_lt_i32 vcc, 4, v181
    s_cbranch_execz K2_RL1
    buffer_load_dwordx4 v[84:87], v180, s[20:23], 0 offen offset:16 sc1
    v_cmpx_lt_i32 vcc, 8, v181
    s_cbranch_execz K2_RL1
    buffer_load_dwordx4 v[88:91], v180, s[20:23], 0 offen offset:32 sc1
    v_cmpx_lt_i32 vcc, 12, v181
    s_cbranch_execz K2_RL1
    buffer_load_dwordx4 v[92:95], v180, s[20:23], 0 offen offset:48 sc1
    v_cmpx_lt_i32 vcc, 16, v181
    s_cbranch_execz K2_RL1
    buffer_load_dwordx4 v[96:99], v180, s[20:23], 0 offen offset:64 sc1
    v_cmpx_lt_i32 vcc, 20, v181
    s_cbranch_execz K2_RL1
    buffer_load_dwordx4 v[100:103], v180, s[20:23], 0 offen offset:80 sc1
K2_RL1:
    s_mov_b64 exec, -1
    s_branch K2_COPY
K2_CPE:
    s_cmp_eq_u32 s59, 0
    s_cbranch_scc1 F_PD
    s_mov_b32 s13, 0x40000
    v_cmp_gt_u32 s[16:17], 50, v240
F_PP:
    v_cmp_ne_u32 vcc, s59, v255
    s_and_b64 vcc, vcc, s[16:17]
    s_cbranch_vccz F_PD
    s_sub_u32 s13, s13, 1
    s_cmp_eq_u32 s13, 0
    s_cbranch_scc1 F_PD
    buffer_load_dword v255, v3, s[20:23], s12 offen offset:4 sc1
    s_sleep 4
    s_waitcnt vmcnt(0)
    s_branch F_PP
F_PD:
    s_mov_b32 s59, 0
    s_waitcnt lgkmcnt(0)
    s_barrier
    s_sub_u32 s52, s42, s43
    s_min_u32 s52, s52, 2048
    s_add_u32 s52, s52, 31
    s_lshr_b32 s52, s52, 5
    s_add_u32 s52, s52, 3
    s_sub_u32 s52, s52, s57
    s_lshr_b32 s44, s52, 2
    s_cmp_eq_u32 s44, 0
    s_cbranch_scc1 K2_RDONE
    s_lshl_b32 s52, s57, 6
    s_add_u32 s52, s52, 18432
    v_lshrrev_b32 v1, 3, v240
    v_lshl_add_u32 v226, v1, 1, s52
    s_lshl_b32 s52, s57, 7
    s_add_u32 s52, s52, 24064
    v_lshrrev_b32 v1, 1, v240
    v_lshl_add_u32 v227, v1, 2, s52
    v_lshl_add_u32 v228, v242, 2, s52
    ds_read_u16 v212, v226 offset:0
    ds_read_u16 v214, v226 offset:16
    ds_read_u16 v216, v226 offset:32
    ds_read_u16 v218, v226 offset:48
    ds_read_b32 v180, v227 offset:0
    ds_read_b32 v181, v227 offset:512
    ds_read_u16 v184, v226 offset:256
    ds_read_u16 v185, v226 offset:272
    ds_read_u16 v186, v226 offset:288
    ds_read_u16 v187, v226 offset:304
    ds_read_b32 v222, v228
    ds_read_b32 v182, v228 offset:512
    s_waitcnt lgkmcnt(0)
    s_add_u32 m0, s46, 1024
    v_and_or_b32 v180, v180, s47, v237
    v_and_or_b32 v181, v181, s47, v237
    buffer_load_dwordx4 v180, s[24:27], 0 offen lds
    s_add_u32 m0, s45, 4096
    s_nop 0
    buffer_load_dwordx4 v[212:213], s[28:31], 0 idxen offen sc1 lds
    s_add_u32 m0, s45, 5120
    s_nop 0
    buffer_load_dwordx4 v[214:215], s[28:31], 0 idxen offen sc1 lds
    s_add_u32 m0, s45, 6144
    s_nop 0
    buffer_load_dwordx4 v[216:217], s[28:31], 0 idxen offen sc1 lds
    s_add_u32 m0, s45, 7168
    s_nop 0
    buffer_load_dwordx4 v[218:219], s[28:31], 0 idxen offen sc1 lds
    v_and_b32 v222, 31, v222
    v_mad_u32_u24 v225, v222, s49, v236
    v_mad_u32_u24 v223, v222, s49, v235
    v_mov_b32 v222, v182
    v_mov_b32 v212, v184
    v_mov_b32 v214, v185
    v_mov_b32 v216, v186
    v_mov_b32 v218, v187
    v_mov_b32 v204, 0
    v_mov_b32 v172, 0
    v_mov_b32 v205, 0
    v_mov_b32 v173, 0
    v_mov_b32 v206, 0
    v_mov_b32 v174, 0
    v_mov_b32 v207, 0
    v_mov_b32 v175, 0
    v_mov_b32 v208, 0
    v_mov_b32 v176, 0
    v_mov_b32 v209, 0
    v_mov_b32 v177, 0
    v_mov_b32 v210, 0
    v_mov_b32 v178, 0
    v_mov_b32 v211, 0
    v_mov_b32 v179, 0
    s_mov_b32 m0, s46
    s_waitcnt vmcnt(0)
    ds_read_b128 v[144:147], v229 offset:4096
    ds_read_b128 v[148:151], v230 offset:4096
    ds_read_b128 v[152:155], v231 offset:4096
    ds_read_b128 v[156:159], v232 offset:4096
    ds_read_b128 v[160:163], v233 offset:1024
    ds_read_b128 v[164:167], v225
    ds_read_b128 v[168:171], v225 offset:32
    buffer_load_dwordx4 v181, s[24:27], 0 offen lds
    s_add_u32 m0, s45, 0
    s_nop 0
    buffer_load_dwordx4 v[212:213], s[28:31], 0 idxen offen sc1 lds
    s_add_u32 m0, s45, 1024
    s_nop 0
    buffer_load_dwordx4 v[214:215], s[28:31], 0 idxen offen sc1 lds
    s_add_u32 m0, s45, 2048
    s_nop 0
    buffer_load_dwordx4 v[216:217], s[28:31], 0 idxen offen sc1 lds
    s_add_u32 m0, s45, 3072
    s_nop 0
    buffer_load_dwordx4 v[218:219], s[28:31], 0 idxen offen sc1 lds
    s_waitcnt lgkmcnt(0)
    v_mfma_f32_32x32x16_bf16 v[80:95], v[144:147], v[8:11], 0
    v_mfma_f32_32x32x16_bf16 v[80:95], v[148:151], v[12:15], v[80:95]
    v_mfma_f32_32x32x16_bf16 v[80:95], v[160:163], v[16:19], v[80:95]
    v_mfma_f32_32x32x16_bf16 v[80:95], v[160:163], v[24:27], v[80:95]
    v_mfma_f32_32x32x16_bf16 v[80:95], v[164:167], v[32:35], v[80:95]
    v_mfma_f32_32x32x16_bf16 v[80:95], v[168:171], v[40:43], v[80:95]
    s_setprio 3
    s_nop 9
K2_LOOP:
    s_cmp_gt_u32 s44, 8
    s_cbranch_scc1 K2_PRD
    s_setprio 2
    s_cmp_gt_u32 s44, 4
    s_cbranch_scc1 K2_PRD
    s_setprio 1
    s_cmp_gt_u32 s44, 1
    s_cbranch_scc1 K2_PRD
    s_setprio 0
K2_PRD:
    v_mfma_f32_32x32x16_bf16 v[64:79], v[204:207], v[172:175], v[64:79]
    v_exp_f32 v180, -v80
    v_exp_f32 v181, -v81
    v_exp_f32 v182, -v82
    v_exp_f32 v183, -v83
    v_mfma_f32_32x32x16_bf16 v[64:79], v[208:211], v[176:179], v[64:79]
    ds_write_b16 v223, v238
    ds_read_b128 v[172:175], v234
    ds_read_b128 v[176:179], v234 offset:32
    ds_write_b16 v223, v239
    v_exp_f32 v184, -v84
    v_exp_f32 v185, -v85
    v_exp_f32 v186, -v86
    v_exp_f32 v187, -v87
    v_mfma_f32_32x32x16_bf16 v[96:111], v[152:155], v[8:11], 0
    v_exp_f32 v188, -v88
    v_exp_f32 v189, -v89
    v_exp_f32 v190, -v90
    v_exp_f32 v191, -v91
    v_mfma_f32_32x32x16_bf16 v[96:111], v[156:159], v[12:15], v[96:111]
    v_exp_f32 v192, -v92
    v_exp_f32 v193, -v93
    v_exp_f32 v194, -v94
    v_exp_f32 v195, -v95
    v_pk_add_f32 v[180:181], v[180:181], 1.0 op_sel_hi:[1,0]
    v_pk_add_f32 v[182:183], v[182:183], 1.0 op_sel_hi:[1,0]
    v_pk_add_f32 v[184:185], v[184:185], 1.0 op_sel_hi:[1,0]
    v_pk_add_f32 v[186:187], v[186:187], 1.0 op_sel_hi:[1,0]
    v_pk_add_f32 v[188:189], v[188:189], 1.0 op_sel_hi:[1,0]
    v_pk_add_f32 v[190:191], v[190:191], 1.0 op_sel_hi:[1,0]
    v_pk_add_f32 v[192:193], v[192:193], 1.0 op_sel_hi:[1,0]
    v_pk_add_f32 v[194:195], v[194:195], 1.0 op_sel_hi:[1,0]
    v_mfma_f32_32x32x16_bf16 v[96:111], v[160:163], v[20:23], v[96:111]
    v_and_b32 v222, 31, v222
    v_mad_u32_u24 v225, v222, s49, v236
    v_mad_u32_u24 v223, v222, s49, v235
    v_rcp_f32 v180, v180
    v_rcp_f32 v181, v181
    v_rcp_f32 v182, v182
    v_rcp_f32 v183, v183
    v_mfma_f32_32x32x16_bf16 v[96:111], v[160:163], v[28:31], v[96:111]
    v_rcp_f32 v184, v184
    v_rcp_f32 v185, v185
    v_rcp_f32 v186, v186
    v_rcp_f32 v187, v187
    v_mfma_f32_32x32x16_bf16 v[96:111], v[164:167], v[36:39], v[96:111]
    v_rcp_f32 v188, v188
    v_rcp_f32 v189, v189
    v_rcp_f32 v190, v190
    v_rcp_f32 v191, v191
    v_mfma_f32_32x32x16_bf16 v[96:111], v[168:171], v[44:47], v[96:111]
    s_waitcnt vmcnt(0)
    ds_read_b128 v[144:147], v229 offset:0
    ds_read_b128 v[148:151], v230 offset:0
    ds_read_b128 v[152:155], v231 offset:0
    ds_read_b128 v[156:159], v232 offset:0
    ds_read_b128 v[160:163], v233 offset:0
    ds_read_b128 v[164:167], v225
    ds_read_b128 v[168:171], v225 offset:32
    ds_read_u16 v212, v226 offset:512
    ds_read_u16 v214, v226 offset:528
    ds_read_u16 v216, v226 offset:544
    ds_read_u16 v218, v226 offset:560
    ds_read_b32 v221, v227 offset:1024
    ds_read_b32 v222, v228 offset:1024
    v_add_u32 v226, 256, v226
    v_add_u32 v227, 512, v227
    v_add_u32 v228, 512, v228
    v_rcp_f32 v192, v192
    v_rcp_f32 v193, v193
    v_rcp_f32 v194, v194
    v_rcp_f32 v195, v195
    v_pk_mul_f32 v[180:181], v[80:81], v[180:181]
    v_pk_mul_f32 v[182:183], v[82:83], v[182:183]
    v_pk_mul_f32 v[184:185], v[84:85], v[184:185]
    v_pk_mul_f32 v[186:187], v[86:87], v[186:187]
    v_pk_mul_f32 v[188:189], v[88:89], v[188:189]
    v_pk_mul_f32 v[190:191], v[90:91], v[190:191]
    v_pk_mul_f32 v[192:193], v[92:93], v[192:193]
    v_pk_mul_f32 v[194:195], v[94:95], v[194:195]
    v_cvt_pk_bf16_f32 v196, v180, v181
    v_cvt_pk_bf16_f32 v197, v182, v183
    v_cvt_pk_bf16_f32 v198, v184, v185
    v_cvt_pk_bf16_f32 v199, v186, v187
    v_cvt_pk_bf16_f32 v200, v188, v189
    v_cvt_pk_bf16_f32 v201, v190, v191
    v_cvt_pk_bf16_f32 v202, v192, v193
    v_cvt_pk_bf16_f32 v203, v194, v195
    s_waitcnt lgkmcnt(13)
    v_mfma_f32_32x32x16_bf16 v[48:63], v[196:199], v[172:175], v[48:63]
    v_exp_f32 v180, -v96
    v_exp_f32 v181, -v97
    v_exp_f32 v182, -v98
    v_exp_f32 v183, -v99
    v_mfma_f32_32x32x16_bf16 v[48:63], v[200:203], v[176:179], v[48:63]
    v_exp_f32 v184, -v100
    v_exp_f32 v185, -v101
    v_exp_f32 v186, -v102
    v_exp_f32 v187, -v103
    s_waitcnt lgkmcnt(0)
    v_mfma_f32_32x32x16_bf16 v[80:95], v[144:147], v[8:11], 0
    s_cmp_gt_u32 s44, 2
    s_cbranch_scc0 K2_SD3
    s_mov_b32 m0, s46
    v_and_or_b32 v220, v221, s47, v237
    buffer_load_dwordx4 v220, s[24:27], 0 offen lds
    s_add_u32 m0, s45, 0
    s_nop 0
    buffer_load_dwordx4 v[212:213], s[28:31], 0 idxen offen sc1 lds
    s_add_u32 m0, s45, 1024
    s_nop 0
    buffer_load_dwordx4 v[214:215], s[28:31], 0 idxen offen sc1 lds
    s_add_u32 m0, s45, 2048
    s_nop 0
    buffer_load_dwordx4 v[216:217], s[28:31], 0 idxen offen sc1 lds
    s_add_u32 m0, s45, 3072
    s_nop 0
    buffer_load_dwordx4 v[218:219], s[28:31], 0 idxen offen sc1 lds
K2_SD3:
    v_exp_f32 v188, -v104
    v_exp_f32 v189, -v105
    v_exp_f32 v190, -v106
    v_exp_f32 v191, -v107
    v_mfma_f32_32x32x16_bf16 v[80:95], v[148:151], v[12:15], v[80:95]
    v_exp_f32 v192, -v108
    v_exp_f32 v193, -v109
    v_exp_f32 v194, -v110
    v_exp_f32 v195, -v111
    v_pk_add_f32 v[180:181], v[180:181], 1.0 op_sel_hi:[1,0]
    v_pk_add_f32 v[182:183], v[182:183], 1.0 op_sel_hi:[1,0]
    v_pk_add_f32 v[184:185], v[184:185], 1.0 op_sel_hi:[1,0]
    v_pk_add_f32 v[186:187], v[186:187], 1.0 op_sel_hi:[1,0]
    v_pk_add_f32 v[188:189], v[188:189], 1.0 op_sel_hi:[1,0]
    v_pk_add_f32 v[190:191], v[190:191], 1.0 op_sel_hi:[1,0]
    v_pk_add_f32 v[192:193], v[192:193], 1.0 op_sel_hi:[1,0]
    v_pk_add_f32 v[194:195], v[194:195], 1.0 op_sel_hi:[1,0]
    v_mfma_f32_32x32x16_bf16 v[80:95], v[160:163], v[16:19], v[80:95]
    v_rcp_f32 v180, v180
    v_rcp_f32 v181, v181
    v_rcp_f32 v182, v182
    v_rcp_f32 v183, v183
    v_mfma_f32_32x32x16_bf16 v[80:95], v[160:163], v[24:27], v[80:95]
    v_rcp_f32 v184, v184
    v_rcp_f32 v185, v185
    v_rcp_f32 v186, v186
    v_rcp_f32 v187, v187
    v_mfma_f32_32x32x16_bf16 v[80:95], v[164:167], v[32:35], v[80:95]
    v_rcp_f32 v188, v188
    v_rcp_f32 v189, v189
    v_rcp_f32 v190, v190
    v_rcp_f32 v191, v191
    v_mfma_f32_32x32x16_bf16 v[80:95], v[168:171], v[40:43], v[80:95]
    v_rcp_f32 v192, v192
    v_rcp_f32 v193, v193
    v_rcp_f32 v194, v194
    v_rcp_f32 v195, v195
    v_pk_mul_f32 v[180:181], v[96:97], v[180:181]
    v_pk_mul_f32 v[182:183], v[98:99], v[182:183]
    v_pk_mul_f32 v[184:185], v[100:101], v[184:185]
    v_pk_mul_f32 v[186:187], v[102:103], v[186:187]
    v_pk_mul_f32 v[188:189], v[104:105], v[188:189]
    v_pk_mul_f32 v[190:191], v[106:107], v[190:191]
    v_pk_mul_f32 v[192:193], v[108:109], v[192:193]
    v_pk_mul_f32 v[194:195], v[110:111], v[194:195]
    v_cvt_pk_bf16_f32 v204, v180, v181
    v_cvt_pk_bf16_f32 v205, v182, v183
    v_cvt_pk_bf16_f32 v206, v184, v185
    v_cvt_pk_bf16_f32 v207, v186, v187
    v_cvt_pk_bf16_f32 v208, v188, v189
    v_cvt_pk_bf16_f32 v209, v190, v191
    v_cvt_pk_bf16_f32 v210, v192, v193
    v_cvt_pk_bf16_f32 v211, v194, v195
    s_sub_u32 s44, s44, 1
    s_cmp_lg_u32 s44, 0
    s_cbranch_scc1 K2_LOOP
K2_LEND:
    s_nop 1
    v_mfma_f32_32x32x16_bf16 v[64:79], v[204:207], v[172:175], v[64:79]
    v_mfma_f32_32x32x16_bf16 v[64:79], v[208:211], v[176:179], v[64:79]
    s_waitcnt vmcnt(0) lgkmcnt(0)
K2_RDONE:
    s_add_u32 s43, s43, 2048
    s_cmp_ge_u32 s43, s42
    s_cbranch_scc1 K2_EPI
    s_barrier
    v_lshlrev_b32 v180, 4, v0
    v_mov_b32 v184, 0
    v_mov_b32 v188, s48
    v_mov_b32 v185, 0
    v_mov_b32 v189, s48
    v_mov_b32 v186, 0
    v_mov_b32 v190, s48
    v_mov_b32 v187, 0
    v_mov_b32 v191, s48
    ds_write_b128 v180, v[184:187] offset:18432
    ds_write_b128 v180, v[188:191] offset:24064
    ds_write_b128 v180, v[188:191] offset:28160
    v_cmp_gt_u32 vcc, 192, v0
    s_mov_b64 exec, vcc
    ds_write_b128 v180, v[188:191] offset:32256
    v_cmp_gt_u32 vcc, 96, v0
    s_mov_b64 exec, vcc
    ds_write_b128 v180, v[184:187] offset:22528
    s_mov_b64 exec, -1
    v_lshl_add_u32 v180, v246, 2, v243
    v_sub_u32 v181, v244, v246
    v_cmpx_lt_i32 vcc, 0, v181
    s_cbranch_execz K2_RL2
    buffer_load_dwordx4 v[80:83], v180, s[20:23], 0 offen offset:0 sc1
    v_cmpx_lt_i32 vcc, 4, v181
    s_cbranch_execz K2_RL2
    buffer_load_dwordx4 v[84:87], v180, s[20:23], 0 offen offset:16 sc1
    v_cmpx_lt_i32 vcc, 8, v181
    s_cbranch_execz K2_RL2
    buffer_load_dwordx4 v[88:91], v180, s[20:23], 0 offen offset:32 sc1
    v_cmpx_lt_i32 vcc, 12, v181
    s_cbranch_execz K2_RL2
    buffer_load_dwordx4 v[92:95], v180, s[20:23], 0 offen offset:48 sc1
    v_cmpx_lt_i32 vcc, 16, v181
    s_cbranch_execz K2_RL2
    buffer_load_dwordx4 v[96:99], v180, s[20:23], 0 offen offset:64 sc1
    v_cmpx_lt_i32 vcc, 20, v181
    s_cbranch_execz K2_RL2
    buffer_load_dwordx4 v[100:103], v180, s[20:23], 0 offen offset:80 sc1
K2_RL2:
    s_mov_b64 exec, -1
    s_waitcnt lgkmcnt(0)
    s_barrier
    s_branch K2_ROUND
K2_EPI:
    s_setprio 3
    v_lshl_add_u32 v1, v241, 4, v249
    buffer_load_dwordx4 v[80:83], v1, s[32:35], 0 offen offset:0
    buffer_load_dwordx4 v[84:87], v1, s[32:35], 0 offen offset:32
    buffer_load_dwordx4 v[88:91], v1, s[32:35], 0 offen offset:64
    buffer_load_dwordx4 v[92:95], v1, s[32:35], 0 offen offset:96
    s_and_b32 s52, s3, 1
    s_lshl_b32 s52, s52, 13
    s_add_u32 s52, s52, 0x5b0000
    s_add_u32 s53, s52, 4096
    buffer_load_dwordx4 v[96:99], v3, s[20:23], s52 offen offset:0 sc1
    buffer_load_dwordx4 v[100:103], v3, s[20:23], s52 offen offset:1024 sc1
    buffer_load_dwordx4 v[104:107], v3, s[20:23], s52 offen offset:2048 sc1
    buffer_load_dwordx4 v[108:111], v3, s[20:23], s52 offen offset:3072 sc1
    buffer_load_dwordx4 v[112:115], v3, s[20:23], s53 offen offset:0 sc1
    buffer_load_dwordx4 v[116:119], v3, s[20:23], s53 offen offset:1024 sc1
    buffer_load_dwordx4 v[120:123], v3, s[20:23], s53 offen offset:2048 sc1
    buffer_load_dwordx4 v[124:127], v3, s[20:23], s53 offen offset:3072 sc1
    s_barrier
    v_add_u32 v4, s45, v3
    s_nop 7
    ds_write_b128 v4, v[48:51] offset:0
    ds_write_b128 v4, v[52:55] offset:1024
    ds_write_b128 v4, v[56:59] offset:2048
    ds_write_b128 v4, v[60:63] offset:3072
    ds_write_b128 v4, v[64:67] offset:4096
    ds_write_b128 v4, v[68:71] offset:5120
    ds_write_b128 v4, v[72:75] offset:6144
    ds_write_b128 v4, v[76:79] offset:7168
    s_waitcnt lgkmcnt(0)
    s_barrier
    s_lshl_b32 s52, s3, 11
    s_add_u32 s52, s52, 48384
    v_add_u32 v4, s52, v3
    ds_read_b128 v[144:147], v4 offset:0
    ds_read_b128 v[148:151], v4 offset:1024
    ds_read_b128 v[152:155], v4 offset:8192
    ds_read_b128 v[156:159], v4 offset:9216
    ds_read_b128 v[160:163], v4 offset:16384
    ds_read_b128 v[164:167], v4 offset:17408
    ds_read_b128 v[168:171], v4 offset:24576
    ds_read_b128 v[172:175], v4 offset:25600
    s_mov_b32 s53, 0x3f317218
    s_waitcnt lgkmcnt(0)
    v_add_f32 v144, v144, v152
    v_add_f32 v160, v160, v168
    v_add_f32 v145, v145, v153
    v_add_f32 v161, v161, v169
    v_add_f32 v146, v146, v154
    v_add_f32 v162, v162, v170
    v_add_f32 v147, v147, v155
    v_add_f32 v163, v163, v171
    v_add_f32 v148, v148, v156
    v_add_f32 v164, v164, v172
    v_add_f32 v149, v149, v157
    v_add_f32 v165, v165, v173
    v_add_f32 v150, v150, v158
    v_add_f32 v166, v166, v174
    v_add_f32 v151, v151, v159
    v_add_f32 v167, v167, v175
    v_add_f32 v144, v144, v160
    v_add_f32 v145, v145, v161
    v_add_f32 v146, v146, v162
    v_add_f32 v147, v147, v163
    v_add_f32 v148, v148, v164
    v_add_f32 v149, v149, v165
    v_add_f32 v150, v150, v166
    v_add_f32 v151, v151, v167
    v_mul_f32 v144, s53, v144
    v_mul_f32 v145, s53, v145
    v_mul_f32 v146, s53, v146
    v_mul_f32 v147, s53, v147
    v_mul_f32 v148, s53, v148
    v_mul_f32 v149, s53, v149
    v_mul_f32 v150, s53, v150
    v_mul_f32 v151, s53, v151
    v_cvt_pk_bf16_f32 v152, v144, v145
    v_cvt_pk_bf16_f32 v153, v146, v147
    v_cvt_pk_bf16_f32 v154, v148, v149
    v_cvt_pk_bf16_f32 v155, v150, v151
    s_lshl_b32 s52, s3, 10
    v_add_u32 v4, s52, v3
    ds_write_b128 v4, v[152:155] offset:0
    s_waitcnt lgkmcnt(0)
    s_barrier
    s_cmp_ge_u32 s3, 2
    s_cbranch_scc1 K2_FIN
    ds_read_b128 v[144:147], v3 offset:0
    ds_read_b128 v[148:151], v3 offset:1024
    ds_read_b128 v[152:155], v3 offset:2048
    ds_read_b128 v[156:159], v3 offset:3072
    s_waitcnt vmcnt(0)
    v_mfma_f32_32x32x16_bf16 v[48:63], v[96:99], v[80:83], 0
    v_mfma_f32_32x32x16_bf16 v[48:63], v[100:103], v[84:87], v[48:63]
    v_mfma_f32_32x32x16_bf16 v[48:63], v[104:107], v[88:91], v[48:63]
    v_mfma_f32_32x32x16_bf16 v[48:63], v[108:111], v[92:95], v[48:63]
    s_waitcnt lgkmcnt(0)
    v_mfma_f32_32x32x16_bf16 v[48:63], v[112:115], v[144:147], v[48:63]
    v_mfma_f32_32x32x16_bf16 v[48:63], v[116:119], v[148:151], v[48:63]
    v_mfma_f32_32x32x16_bf16 v[48:63], v[120:123], v[152:155], v[48:63]
    v_mfma_f32_32x32x16_bf16 v[48:63], v[124:127], v[156:159], v[48:63]
    s_mov_b32 s53, 0x3fb8aa3b
    s_lshl_b32 s52, s3, 6
    v_lshl_add_u32 v1, v241, 3, v249
    s_nop 15
    v_cvt_pk_bf16_f32 v180, v48, v49
    v_cvt_pk_bf16_f32 v181, v50, v51
    v_cvt_pk_bf16_f32 v182, v52, v53
    v_cvt_pk_bf16_f32 v183, v54, v55
    v_cvt_pk_bf16_f32 v184, v56, v57
    v_cvt_pk_bf16_f32 v185, v58, v59
    v_cvt_pk_bf16_f32 v186, v60, v61
    v_cvt_pk_bf16_f32 v187, v62, v63
    v_lshlrev_b32 v48, 16, v180
    v_and_b32 v49, 0xffff0000, v180
    v_lshlrev_b32 v50, 16, v181
    v_and_b32 v51, 0xffff0000, v181
    v_lshlrev_b32 v52, 16, v182
    v_and_b32 v53, 0xffff0000, v182
    v_lshlrev_b32 v54, 16, v183
    v_and_b32 v55, 0xffff0000, v183
    v_lshlrev_b32 v56, 16, v184
    v_and_b32 v57, 0xffff0000, v184
    v_lshlrev_b32 v58, 16, v185
    v_and_b32 v59, 0xffff0000, v185
    v_lshlrev_b32 v60, 16, v186
    v_and_b32 v61, 0xffff0000, v186
    v_lshlrev_b32 v62, 16, v187
    v_and_b32 v63, 0xffff0000, v187
    v_mul_f32 v180, s53, v48
    v_mul_f32 v181, s53, v49
    v_mul_f32 v182, s53, v50
    v_mul_f32 v183, s53, v51
    v_mul_f32 v184, s53, v52
    v_mul_f32 v185, s53, v53
    v_mul_f32 v186, s53, v54
    v_mul_f32 v187, s53, v55
    v_mul_f32 v188, s53, v56
    v_mul_f32 v189, s53, v57
    v_mul_f32 v190, s53, v58
    v_mul_f32 v191, s53, v59
    v_mul_f32 v192, s53, v60
    v_mul_f32 v193, s53, v61
    v_mul_f32 v194, s53, v62
    v_mul_f32 v195, s53, v63
    v_exp_f32 v180, -v180
    v_exp_f32 v181, -v181
    v_exp_f32 v182, -v182
    v_exp_f32 v183, -v183
    v_exp_f32 v184, -v184
    v_exp_f32 v185, -v185
    v_exp_f32 v186, -v186
    v_exp_f32 v187, -v187
    v_exp_f32 v188, -v188
    v_exp_f32 v189, -v189
    v_exp_f32 v190, -v190
    v_exp_f32 v191, -v191
    v_exp_f32 v192, -v192
    v_exp_f32 v193, -v193
    v_exp_f32 v194, -v194
    v_exp_f32 v195, -v195
    v_add_f32 v180, 1.0, v180
    v_add_f32 v181, 1.0, v181
    v_add_f32 v182, 1.0, v182
    v_add_f32 v183, 1.0, v183
    v_add_f32 v184, 1.0, v184
    v_add_f32 v185, 1.0, v185
    v_add_f32 v186, 1.0, v186
    v_add_f32 v187, 1.0, v187
    v_add_f32 v188, 1.0, v188
    v_add_f32 v189, 1.0, v189
    v_add_f32 v190, 1.0, v190
    v_add_f32 v191, 1.0, v191
    v_add_f32 v192, 1.0, v192
    v_add_f32 v193, 1.0, v193
    v_add_f32 v194, 1.0, v194
    v_add_f32 v195, 1.0, v195
    v_rcp_f32 v180, v180
    v_rcp_f32 v181, v181
    v_rcp_f32 v182, v182
    v_rcp_f32 v183, v183
    v_rcp_f32 v184, v184
    v_rcp_f32 v185, v185
    v_rcp_f32 v186, v186
    v_rcp_f32 v187, v187
    v_rcp_f32 v188, v188
    v_rcp_f32 v189, v189
    v_rcp_f32 v190, v190
    v_rcp_f32 v191, v191
    v_rcp_f32 v192, v192
    v_rcp_f32 v193, v193
    v_rcp_f32 v194, v194
    v_rcp_f32 v195, v195
    v_mul_f32 v180, v48, v180
    v_mul_f32 v181, v49, v181
    v_mul_f32 v182, v50, v182
    v_mul_f32 v183, v51, v183
    v_mul_f32 v184, v52, v184
    v_mul_f32 v185, v53, v185
    v_mul_f32 v186, v54, v186
    v_mul_f32 v187, v55, v187
    v_mul_f32 v188, v56, v188
    v_mul_f32 v189, v57, v189
    v_mul_f32 v190, v58, v190
    v_mul_f32 v191, v59, v191
    v_mul_f32 v192, v60, v192
    v_mul_f32 v193, v61, v193
    v_mul_f32 v194, v62, v194
    v_mul_f32 v195, v63, v195
    v_cvt_pk_bf16_f32 v48, v180, v181
    v_cvt_pk_bf16_f32 v49, v182, v183
    v_cvt_pk_bf16_f32 v50, v184, v185
    v_cvt_pk_bf16_f32 v51, v186, v187
    v_cvt_pk_bf16_f32 v52, v188, v189
    v_cvt_pk_bf16_f32 v53, v190, v191
    v_cvt_pk_bf16_f32 v54, v192, v193
    v_cvt_pk_bf16_f32 v55, v194, v195
    s_mov_b64 exec, s[50:51]
    buffer_store_dwordx2 v[48:49], v1, s[36:39], s52 offen offset:0
    buffer_store_dwordx2 v[50:51], v1, s[36:39], s52 offen offset:16
    buffer_store_dwordx2 v[52:53], v1, s[36:39], s52 offen offset:32
    buffer_store_dwordx2 v[54:55], v1, s[36:39], s52 offen offset:48
K2_FIN:
K2_END:
    s_endpgm
.section .rodata,"a"
.p2align 6
.amdhsa_kernel standalone__mpnn_edge_mlp__graph_kernel
  .amdhsa_next_free_vgpr 256
  .amdhsa_next_free_sgpr 100
  .amdhsa_accum_offset 256
  .amdhsa_group_segment_fixed_size 0
  .amdhsa_kernarg_size 72
  .amdhsa_user_sgpr_count 2
  .amdhsa_user_sgpr_kernarg_segment_ptr 1
  .amdhsa_system_sgpr_workgroup_id_x 1
.end_amdhsa_kernel
```
